```python
import torch

def _softmax(x, axis=-1):
    return torch.softmax(x, dim=axis)
def _gelu(x):
    return torch.nn.functional.gelu(x, approximate="tanh")
def _silu(x):
    return torch.nn.functional.silu(x)
def _sigmoid(x):
    return torch.sigmoid(x)
def _layernorm(x, axis=-1, eps=1e-5):
    m = x.mean(dim=axis, keepdim=True)
    v = x.var(dim=axis, keepdim=True, unbiased=False)
    return (x - m) / torch.sqrt(v + eps)
def _scatter_add(tgt, idx, src, axis=0):
    return tgt.clone().index_add_(axis, idx, src)
def _segment_sum(src, seg, n):
    out = torch.zeros((n,) + src.shape[1:], dtype=src.dtype)
    return out.index_add_(0, seg, src)
def _pad(x, pw):
    flat = tuple(v for pair in reversed(pw) for v in pair)
    return torch.nn.functional.pad(x, flat)

kernel_name = 'recurrent_scan__mha_block__moe_arch_mod__prompt'

def setup_inputs():

    _w = (lambda a: (lambda t: t.to(torch.bfloat16) if t.is_floating_point() else t)(torch.as_tensor(a)))
    def _A_setup():
        B, S, D, H = 1, 2048, 640, 32
        return {
            "x": _w((lambda *s: torch.randn(*s, dtype=torch.bfloat16) * 0.05)(B, S, D)),
            "wqkv": _w((lambda *s: torch.randn(*s, dtype=torch.bfloat16) * 0.05)(D, 3 * D)),
            "wo": _w((lambda *s: torch.randn(*s, dtype=torch.bfloat16) * 0.05)(D, D)),
        }
    _A_in = _A_setup()

    def _B_setup():
        B, S, D, F, C = 1, 2048, 640, 1536, 8
        return {
            "x": _w((lambda *s: torch.randn(*s, dtype=torch.bfloat16) * 0.05)(B, S, D)),
            "w_r": _w((lambda *s: torch.randn(*s, dtype=torch.bfloat16) * 0.05)(D)),
            "w_gate": _w((lambda *s: torch.randn(*s, dtype=torch.bfloat16) * 0.05)(D, F)),
            "w_up": _w((lambda *s: torch.randn(*s, dtype=torch.bfloat16) * 0.05)(D, F)),
            "w_down": _w((lambda *s: torch.randn(*s, dtype=torch.bfloat16) * 0.05)(F, D)),
        }
    _B_in = _B_setup()

    return {
        "A_x": _A_in["x"],
        "A_wqkv": _A_in["wqkv"],
        "A_wo": _A_in["wo"],
        "B_x": _B_in["x"],
        "B_w_r": _B_in["w_r"],
        "B_w_gate": _B_in["w_gate"],
        "B_w_up": _B_in["w_up"],
        "B_w_down": _B_in["w_down"],
    }

def reference(A_x, A_wqkv, A_wo, B_x, B_w_r, B_w_gate, B_w_up, B_w_down):
    def _A_ref(x, wqkv, wo):
        B, S, D = x.shape
        H = 32
        Dh = D // H
        qkv = (lambda x, *d: x.permute(*d))((x @ wqkv).reshape(B, S, 3, H, Dh), 2, 0, 3, 1, 4)
        q, k, v = qkv[0], qkv[1], qkv[2]
        scores = torch.einsum("bhqd,bhkd->bhqk", q, k) * (Dh ** -0.5)
        p = _softmax(scores, axis=-1)
        o = torch.einsum("bhqk,bhkd->bhqd", p, v)
        return (lambda x, *d: x.permute(*d))(o, 0, 2, 1, 3).reshape(B, S, D) @ wo

    def _B_ref(x, w_r, w_gate, w_up, w_down):
        B, S, D = x.shape
        C = 8
        r = x @ w_r
        idx = torch.argsort(-r, axis=-1)[:, :C]
        idx_e = (lambda x, n, axis: torch.repeat_interleave(x, n, dim=axis))(idx.reshape(B, C, 1), D, axis=2)
        x_sel = (lambda x, i, axis: torch.take_along_dim(x, i, dim=axis))(x, idx_e, axis=1)
        g = _silu(x_sel @ w_gate)
        u = x_sel @ w_up
        y = (g * u) @ w_down
        r_sel = _sigmoid((lambda x, i, axis: torch.take_along_dim(x, i, dim=axis))(r, idx, axis=1))
        y = y * r_sel.reshape(B, C, 1)
        b_off = (torch.arange(B) * S).reshape(B, 1)
        flat_idx = (idx + b_off).reshape(B * C)
        zero = (x * 0.0).reshape(B * S, D)
        upd = _scatter_add(zero, flat_idx, y.reshape(B * C, D), axis=0)
        return x + upd.reshape(B, S, D)

    x = A_x
    xn = _layernorm(x, axis=-1)
    s = _A_ref(xn, A_wqkv, A_wo)
    g = _silu(_B_ref(xn, B_w_r, B_w_gate, B_w_up, B_w_down))
    return x + s * g
```

```asm
; @launch kernel=qkv_kernel grid=(256,1,1) block=(512,1,1) lds=149632
; @launch kernel=attn_kernel grid=(256,1,1) block=(768,1,1) lds=163840
.amdgcn_target "amdgcn-amd-amdhsa--gfx950"
.text
.globl qkv_kernel
.p2align 8
.type qkv_kernel,@function
qkv_kernel:
    s_cmp_ge_u32 s2, 256
    s_cbranch_scc1 L1_end
    s_load_dwordx4 s[4:7], s[0:1], 0
    s_load_dwordx4 s[40:43], s[0:1], 72
    v_lshrrev_b32 v1, 6, v0
    v_and_b32 v0, 63, v0
    s_mov_b32 s55, 0x7f000000
    v_readfirstlane_b32 s20, v1
    s_cmp_lt_u32 s2, 64
    s_cbranch_scc1 L1_spare
    s_sub_u32 s24, s2, 64
    s_lshr_b32 s23, s24, 3
    s_mul_i32 s26, s23, 43
    s_lshr_b32 s26, s26, 8
    s_mul_i32 s27, s26, 6
    s_sub_u32 s27, s23, s27
    s_bfe_u32 s21, s24, 0x20001
    s_lshl_b32 s21, s21, 2
    s_add_u32 s21, s21, s26
    s_and_b32 s22, s24, 1
    s_mul_i32 s22, s22, 6
    s_add_u32 s22, s22, s27
    s_mov_b32 s33, s26
    s_mov_b32 s34, s27
    s_mov_b32 s39, 36992
    s_cmp_ge_u32 s20, 4
    s_cbranch_scc1 L1_compute
    s_lshl_b32 s29, s21, 7
    s_lshl_b32 s30, s20, 5
    s_add_u32 s29, s29, s30
    v_lshrrev_b32 v11, 3, v0
    v_add_u32 v11, s29, v11
    v_mul_u32_u24 v11, 1280, v11
    v_lshrrev_b32 v12, 4, v0
    v_and_b32 v13, 2, v12
    v_lshlrev_b32 v13, 1, v13
    v_xor_b32 v12, v12, v13
    v_and_b32 v13, 7, v0
    v_xor_b32 v12, v12, v13
    v_lshl_add_u32 v2, v12, 4, v11
    v_xor_b32 v12, 4, v12
    v_lshl_add_u32 v3, v12, 4, v11
    v_add_u32 v3, 9216, v3
    v_add_u32 v4, 18432, v2
    v_add_u32 v5, 18432, v3
    s_mul_i32 s29, s20, 61440
    s_mul_i32 s30, s22, 320
    s_add_u32 s29, s29, s30
    v_lshlrev_b32 v11, 4, v0
    v_add_u32 v11, s29, v11
    v_mul_u32_u24 v12, 3277, v0
    s_movk_i32 s30, 3520
    v_add_u32 v13, 0, v12
    v_lshrrev_b32 v13, 16, v13
    v_mad_u32_u24 v6, v13, s30, v11
    v_add_u32 v13, 209728, v12
    v_lshrrev_b32 v13, 16, v13
    v_mad_u32_u24 v7, v13, s30, v11
    v_add_u32 v13, 419456, v12
    v_lshrrev_b32 v13, 16, v13
    v_mad_u32_u24 v8, v13, s30, v11
    v_add_u32 v13, 629184, v12
    v_lshrrev_b32 v13, 16, v13
    v_mad_u32_u24 v9, v13, s30, v11
    v_add_u32 v13, 838912, v12
    v_lshrrev_b32 v13, 16, v13
    v_mad_u32_u24 v10, v13, s30, v11
    v_add_u32 v10, 4096, v10
    s_lshl_b32 s25, s20, 12
    s_mul_i32 s26, s20, 5152
    s_add_u32 s26, s26, 16384
    s_lshl_b32 s29, s34, 1
    s_min_u32 s29, s29, 9
    s_mul_i32 s30, s33, 5
    s_add_u32 s30, s30, 1
    s_lshr_b32 s30, s30, 1
    s_add_u32 s29, s29, s30
    s_cmp_ge_u32 s29, 10
    s_cselect_b32 s30, 10, 0
    s_sub_u32 s29, s29, s30
    s_lshl_b32 s27, s29, 7
    s_mul_i32 s28, s29, 245760
    s_lshl_b32 s30, s20, 12
    v_mov_b32 v15, s30
    s_waitcnt lgkmcnt(0)
    s_mov_b32 s8, s4
    s_mov_b32 s9, s5
    s_mov_b32 s10, 0x280000
    s_mov_b32 s11, 0x20000
    s_mov_b32 s12, s6
    s_mov_b32 s13, s7
    s_mov_b32 s14, 0x258000
    s_mov_b32 s15, 0x20000
    s_add_u32 m0, s25, 0
    s_nop 0
    buffer_load_dwordx4 v2, s[8:11], s27 offen offset:0 lds
    buffer_load_dwordx4 v3, s[8:11], s27 offen offset:1024 lds
    buffer_load_dwordx4 v4, s[8:11], s27 offen offset:2048 lds
    buffer_load_dwordx4 v5, s[8:11], s27 offen offset:3072 lds
    s_add_u32 s27, s27, 128
    s_cmp_eq_u32 s27, 1280
    s_cselect_b32 s27, 0, s27
    s_add_u32 m0, s26, 0
    s_nop 0
    buffer_load_dwordx4 v6, s[12:15], s28 offen offset:0 lds
    buffer_load_dwordx4 v7, s[12:15], s28 offen offset:1024 lds
    buffer_load_dwordx4 v8, s[12:15], s28 offen offset:2048 lds
    buffer_load_dwordx4 v9, s[12:15], s28 offen offset:3072 lds
    s_add_u32 m0, s26, 4096
    s_nop 0
    buffer_load_dwordx4 v10, s[12:15], s28 offen lds
    s_add_u32 s28, s28, 245760
    s_cmp_eq_u32 s28, 2457600
    s_cselect_b32 s28, 0, s28
    s_mov_b32 s16, s42
    s_mov_b32 s17, s43
    s_mov_b32 s18, 0x1100000
    s_mov_b32 s19, 0x20000
    s_mov_b32 s44, s40
    s_mov_b32 s45, s41
    s_mov_b32 s46, 0x100
    s_mov_b32 s47, 0x20000
    s_add_u32 m0, s25, 36992
    s_nop 0
    buffer_load_dwordx4 v2, s[8:11], s27 offen offset:0 lds
    buffer_load_dwordx4 v3, s[8:11], s27 offen offset:1024 lds
    buffer_load_dwordx4 v4, s[8:11], s27 offen offset:2048 lds
    buffer_load_dwordx4 v5, s[8:11], s27 offen offset:3072 lds
    s_add_u32 s27, s27, 128
    s_cmp_eq_u32 s27, 1280
    s_cselect_b32 s27, 0, s27
    s_waitcnt vmcnt(4)
    s_barrier
    s_add_u32 m0, s26, 36992
    s_nop 0
    buffer_load_dwordx4 v6, s[12:15], s28 offen offset:0 lds
    buffer_load_dwordx4 v7, s[12:15], s28 offen offset:1024 lds
    buffer_load_dwordx4 v8, s[12:15], s28 offen offset:2048 lds
    buffer_load_dwordx4 v9, s[12:15], s28 offen offset:3072 lds
    s_add_u32 m0, s26, 41088
    s_nop 0
    buffer_load_dwordx4 v10, s[12:15], s28 offen lds
    s_add_u32 s28, s28, 245760
    s_cmp_eq_u32 s28, 2457600
    s_cselect_b32 s28, 0, s28
    s_add_u32 m0, s25, 73984
    s_nop 0
    buffer_load_dwordx4 v2, s[8:11], s27 offen offset:0 lds
    buffer_load_dwordx4 v3, s[8:11], s27 offen offset:1024 lds
    buffer_load_dwordx4 v4, s[8:11], s27 offen offset:2048 lds
    buffer_load_dwordx4 v5, s[8:11], s27 offen offset:3072 lds
    s_add_u32 s27, s27, 128
    s_cmp_eq_u32 s27, 1280
    s_cselect_b32 s27, 0, s27
    s_waitcnt vmcnt(4)
    s_barrier
    s_add_u32 m0, s26, 73984
    s_nop 0
    buffer_load_dwordx4 v6, s[12:15], s28 offen offset:0 lds
    buffer_load_dwordx4 v7, s[12:15], s28 offen offset:1024 lds
    buffer_load_dwordx4 v8, s[12:15], s28 offen offset:2048 lds
    buffer_load_dwordx4 v9, s[12:15], s28 offen offset:3072 lds
    s_add_u32 m0, s26, 78080
    s_nop 0
    buffer_load_dwordx4 v10, s[12:15], s28 offen lds
    s_add_u32 s28, s28, 245760
    s_cmp_eq_u32 s28, 2457600
    s_cselect_b32 s28, 0, s28
    s_add_u32 m0, s25, 110976
    s_nop 0
    buffer_load_dwordx4 v2, s[8:11], s27 offen offset:0 lds
    buffer_load_dwordx4 v3, s[8:11], s27 offen offset:1024 lds
    buffer_load_dwordx4 v4, s[8:11], s27 offen offset:2048 lds
    buffer_load_dwordx4 v5, s[8:11], s27 offen offset:3072 lds
    s_add_u32 s27, s27, 128
    s_cmp_eq_u32 s27, 1280
    s_cselect_b32 s27, 0, s27
    s_waitcnt vmcnt(4)
    s_barrier
    s_add_u32 m0, s26, 110976
    s_nop 0
    buffer_load_dwordx4 v6, s[12:15], s28 offen offset:0 lds
    buffer_load_dwordx4 v7, s[12:15], s28 offen offset:1024 lds
    buffer_load_dwordx4 v8, s[12:15], s28 offen offset:2048 lds
    buffer_load_dwordx4 v9, s[12:15], s28 offen offset:3072 lds
    s_add_u32 m0, s26, 115072
    s_nop 0
    buffer_load_dwordx4 v10, s[12:15], s28 offen lds
    s_add_u32 s28, s28, 245760
    s_cmp_eq_u32 s28, 2457600
    s_cselect_b32 s28, 0, s28
    s_add_u32 m0, s25, 0
    s_nop 0
    buffer_load_dwordx4 v2, s[8:11], s27 offen offset:0 lds
    buffer_load_dwordx4 v3, s[8:11], s27 offen offset:1024 lds
    buffer_load_dwordx4 v4, s[8:11], s27 offen offset:2048 lds
    buffer_load_dwordx4 v5, s[8:11], s27 offen offset:3072 lds
    s_add_u32 s27, s27, 128
    s_cmp_eq_u32 s27, 1280
    s_cselect_b32 s27, 0, s27
    s_add_u32 m0, s26, 0
    s_nop 0
    buffer_load_dwordx4 v6, s[12:15], s28 offen offset:0 lds
    buffer_load_dwordx4 v7, s[12:15], s28 offen offset:1024 lds
    buffer_load_dwordx4 v8, s[12:15], s28 offen offset:2048 lds
    buffer_load_dwordx4 v9, s[12:15], s28 offen offset:3072 lds
    s_add_u32 m0, s26, 4096
    s_nop 0
    buffer_load_dwordx4 v10, s[12:15], s28 offen lds
    s_add_u32 s28, s28, 245760
    s_cmp_eq_u32 s28, 2457600
    s_cselect_b32 s28, 0, s28
    s_waitcnt vmcnt(9)
    s_barrier
    s_add_u32 m0, s25, 36992
    s_nop 0
    buffer_load_dwordx4 v2, s[8:11], s27 offen offset:0 lds
    buffer_load_dwordx4 v3, s[8:11], s27 offen offset:1024 lds
    buffer_load_dwordx4 v4, s[8:11], s27 offen offset:2048 lds
    buffer_load_dwordx4 v5, s[8:11], s27 offen offset:3072 lds
    s_add_u32 s27, s27, 128
    s_cmp_eq_u32 s27, 1280
    s_cselect_b32 s27, 0, s27
    s_add_u32 m0, s26, 36992
    s_nop 0
    buffer_load_dwordx4 v6, s[12:15], s28 offen offset:0 lds
    buffer_load_dwordx4 v7, s[12:15], s28 offen offset:1024 lds
    buffer_load_dwordx4 v8, s[12:15], s28 offen offset:2048 lds
    buffer_load_dwordx4 v9, s[12:15], s28 offen offset:3072 lds
    s_add_u32 m0, s26, 41088
    s_nop 0
    buffer_load_dwordx4 v10, s[12:15], s28 offen lds
    s_add_u32 s28, s28, 245760
    s_cmp_eq_u32 s28, 2457600
    s_cselect_b32 s28, 0, s28
    s_waitcnt vmcnt(9)
    s_barrier
    s_add_u32 m0, s25, 73984
    s_nop 0
    buffer_load_dwordx4 v2, s[8:11], s27 offen offset:0 lds
    buffer_load_dwordx4 v3, s[8:11], s27 offen offset:1024 lds
    buffer_load_dwordx4 v4, s[8:11], s27 offen offset:2048 lds
    buffer_load_dwordx4 v5, s[8:11], s27 offen offset:3072 lds
    s_add_u32 s27, s27, 128
    s_cmp_eq_u32 s27, 1280
    s_cselect_b32 s27, 0, s27
    s_add_u32 m0, s26, 73984
    s_nop 0
    buffer_load_dwordx4 v6, s[12:15], s28 offen offset:0 lds
    buffer_load_dwordx4 v7, s[12:15], s28 offen offset:1024 lds
    buffer_load_dwordx4 v8, s[12:15], s28 offen offset:2048 lds
    buffer_load_dwordx4 v9, s[12:15], s28 offen offset:3072 lds
    s_add_u32 m0, s26, 78080
    s_nop 0
    buffer_load_dwordx4 v10, s[12:15], s28 offen lds
    s_add_u32 s28, s28, 245760
    s_cmp_eq_u32 s28, 2457600
    s_cselect_b32 s28, 0, s28
    s_waitcnt vmcnt(9)
    s_barrier
    s_add_u32 m0, s25, 110976
    s_nop 0
    buffer_load_dwordx4 v2, s[8:11], s27 offen offset:0 lds
    buffer_load_dwordx4 v3, s[8:11], s27 offen offset:1024 lds
    buffer_load_dwordx4 v4, s[8:11], s27 offen offset:2048 lds
    buffer_load_dwordx4 v5, s[8:11], s27 offen offset:3072 lds
    s_add_u32 s27, s27, 128
    s_cmp_eq_u32 s27, 1280
    s_cselect_b32 s27, 0, s27
    s_add_u32 m0, s26, 110976
    s_nop 0
    buffer_load_dwordx4 v6, s[12:15], s28 offen offset:0 lds
    buffer_load_dwordx4 v7, s[12:15], s28 offen offset:1024 lds
    buffer_load_dwordx4 v8, s[12:15], s28 offen offset:2048 lds
    buffer_load_dwordx4 v9, s[12:15], s28 offen offset:3072 lds
    s_add_u32 m0, s26, 115072
    s_nop 0
    buffer_load_dwordx4 v10, s[12:15], s28 offen lds
    s_add_u32 s28, s28, 245760
    s_cmp_eq_u32 s28, 2457600
    s_cselect_b32 s28, 0, s28
    s_waitcnt vmcnt(9)
    s_barrier
    s_add_u32 m0, s25, 0
    s_nop 0
    buffer_load_dwordx4 v2, s[8:11], s27 offen offset:0 lds
    buffer_load_dwordx4 v3, s[8:11], s27 offen offset:1024 lds
    buffer_load_dwordx4 v4, s[8:11], s27 offen offset:2048 lds
    buffer_load_dwordx4 v5, s[8:11], s27 offen offset:3072 lds
    s_add_u32 s27, s27, 128
    s_cmp_eq_u32 s27, 1280
    s_cselect_b32 s27, 0, s27
    s_add_u32 m0, s26, 0
    s_nop 0
    buffer_load_dwordx4 v6, s[12:15], s28 offen offset:0 lds
    buffer_load_dwordx4 v7, s[12:15], s28 offen offset:1024 lds
    buffer_load_dwordx4 v8, s[12:15], s28 offen offset:2048 lds
    buffer_load_dwordx4 v9, s[12:15], s28 offen offset:3072 lds
    s_add_u32 m0, s26, 4096
    s_nop 0
    buffer_load_dwordx4 v10, s[12:15], s28 offen lds
    s_add_u32 s28, s28, 245760
    s_cmp_eq_u32 s28, 2457600
    s_cselect_b32 s28, 0, s28
    s_mov_b64 exec, 1
    buffer_load_dword v14, v15, s[44:47], 0 offen offset:128 sc1
    s_mov_b64 exec, -1
    s_waitcnt vmcnt(10)
    s_barrier
    s_add_u32 m0, s25, 36992
    s_nop 0
    buffer_load_dwordx4 v2, s[8:11], s27 offen offset:0 lds
    buffer_load_dwordx4 v3, s[8:11], s27 offen offset:1024 lds
    buffer_load_dwordx4 v4, s[8:11], s27 offen offset:2048 lds
    buffer_load_dwordx4 v5, s[8:11], s27 offen offset:3072 lds
    s_add_u32 s27, s27, 128
    s_cmp_eq_u32 s27, 1280
    s_cselect_b32 s27, 0, s27
    s_add_u32 m0, s26, 36992
    s_nop 0
    buffer_load_dwordx4 v6, s[12:15], s28 offen offset:0 lds
    buffer_load_dwordx4 v7, s[12:15], s28 offen offset:1024 lds
    buffer_load_dwordx4 v8, s[12:15], s28 offen offset:2048 lds
    buffer_load_dwordx4 v9, s[12:15], s28 offen offset:3072 lds
    s_add_u32 m0, s26, 41088
    s_nop 0
    buffer_load_dwordx4 v10, s[12:15], s28 offen lds
    s_add_u32 s28, s28, 245760
    s_cmp_eq_u32 s28, 2457600
    s_cselect_b32 s28, 0, s28
    s_waitcnt vmcnt(10)
    s_barrier
    s_waitcnt vmcnt(0)
    s_cmp_eq_u32 s20, 0
    s_cbranch_scc1 L1_ld_w0
    s_barrier
    s_endpgm
L1_ld_w0:
    v_readfirstlane_b32 s31, v14
    s_movk_i32 s32, 7680
    v_and_b32 v16, 31, v0
    v_lshlrev_b32 v16, 4, v16
    v_lshrrev_b32 v17, 5, v0
    v_lshl_add_u32 v16, v17, 13, v16
    s_lshl_b32 s29, s21, 9
    s_add_u32 s29, s29, 0xb00000
    v_add_u32 v16, s29, v16
    s_mul_i32 s29, s22, 640
    s_add_u32 s29, s29, 0xb04000
    v_min_u32 v17, 39, v0
    v_lshlrev_b32 v17, 4, v17
    v_add_u32 v12, 148992, v17
    v_add_u32 v17, s29, v17
    v_lshlrev_b32 v11, 4, v0
    v_add_u32 v11, 147968, v11
    s_cmp_lt_u32 s31, 64
    s_cbranch_scc1 L1_ld_late
    buffer_load_dwordx4 v[20:23], v16, s[16:19], 0 offen sc1
    buffer_load_dwordx4 v[24:27], v17, s[16:19], 0 offen sc1
    buffer_load_dwordx4 v[28:31], v17, s[16:19], s32 offen sc1
    s_barrier
    s_barrier
L1_ld_fin:
    s_waitcnt vmcnt(0)
    ds_write_b128 v11, v[20:23]
    v_add_f32 v24, v24, v28
    v_add_f32 v25, v25, v29
    v_add_f32 v26, v26, v30
    v_add_f32 v27, v27, v31
    ds_write_b128 v12, v[24:27]
    s_waitcnt lgkmcnt(0)
    s_barrier
    s_endpgm
L1_ld_late:
    s_mov_b64 exec, 1
    buffer_load_dword v14, v15, s[44:47], 0 offen offset:128 sc1
    s_mov_b64 exec, -1
    s_barrier
    s_barrier
    s_mov_b32 s30, 65536
L1_ld_spin:
    s_waitcnt vmcnt(0)
    v_readfirstlane_b32 s29, v14
    s_cmp_ge_u32 s29, 64
    s_cbranch_scc1 L1_ld_got
    s_sleep 2
    s_mov_b64 exec, 1
    buffer_load_dword v14, v15, s[44:47], 0 offen offset:128 sc1
    s_mov_b64 exec, -1
    s_sub_u32 s30, s30, 1
    s_cbranch_scc0 L1_ld_spin
L1_ld_got:
    buffer_load_dwordx4 v[20:23], v16, s[16:19], 0 offen sc1
    buffer_load_dwordx4 v[24:27], v17, s[16:19], 0 offen sc1
    buffer_load_dwordx4 v[28:31], v17, s[16:19], s32 offen sc1
    s_branch L1_ld_fin
L1_compute:
    s_bfe_u32 s24, s20, 0x10001
    s_and_b32 s25, s20, 1
    s_waitcnt lgkmcnt(0)
    s_mov_b32 s16, s42
    s_mov_b32 s17, s43
    s_mov_b32 s18, 0x1100000
    s_mov_b32 s19, 0x20000
    s_cmp_lg_u32 s20, 4
    s_cbranch_scc1 L1_notouch0
    s_getpc_b64 s[44:45]
Lpc_411:
    s_add_u32 s44, s44, qkv_kernel-Lpc_411
    s_addc_u32 s45, s45, ((qkv_kernel-Lpc_411)>>32)
    s_mov_b32 s46, L1_spare-qkv_kernel
    s_mov_b32 s47, 0x20000
    v_lshlrev_b32 v166, 7, v0
    buffer_load_dword v161, v166, s[44:47], 0 offen
L1_notouch0:
    s_lshl_b32 s55, s22, 4
    s_add_u32 s55, s55, s21
    s_lshl_b32 s55, s55, 5
    s_lshl_b32 s32, s25, 1
    s_add_u32 s32, s32, s24
    s_add_u32 s55, s55, s32
    s_lshl_b32 s55, s55, 2
    s_add_u32 s55, s55, 0xc10000
    v_and_b32 v84, 15, v0
    v_lshrrev_b32 v85, 4, v0
    v_lshrrev_b32 v86, 1, v84
    v_and_b32 v87, 2, v86
    v_lshlrev_b32 v87, 1, v87
    v_xor_b32 v86, v86, v87
    v_lshlrev_b32 v87, 1, v85
    v_xor_b32 v86, v86, v87
    v_lshlrev_b32 v87, 7, v84
    v_lshl_add_u32 v156, v86, 4, v87
    s_lshl_b32 s32, s24, 13
    v_add_u32 v156, s32, v156
    v_xor_b32 v157, 16, v156
    v_mul_u32_u24 v86, 5152, v85
    v_lshrrev_b32 v87, 2, v84
    v_mul_u32_u24 v87, 320, v87
    v_add_u32 v86, v86, v87
    v_and_b32 v87, 3, v0
    v_mul_u32_u24 v87, 40, v87
    v_add_u32 v86, v86, v87
    s_mul_i32 s32, s25, 160
    s_add_u32 s32, s32, 16384
    v_add_u32 v158, s32, v86
    v_mov_b32 v4, 0
    v_mov_b32 v5, 0
    v_mov_b32 v6, 0
    v_mov_b32 v7, 0
    v_mov_b32 v8, 0
    v_mov_b32 v9, 0
    v_mov_b32 v10, 0
    v_mov_b32 v11, 0
    v_mov_b32 v12, 0
    v_mov_b32 v13, 0
    v_mov_b32 v14, 0
    v_mov_b32 v15, 0
    v_mov_b32 v16, 0
    v_mov_b32 v17, 0
    v_mov_b32 v18, 0
    v_mov_b32 v19, 0
    v_mov_b32 v20, 0
    v_mov_b32 v21, 0
    v_mov_b32 v22, 0
    v_mov_b32 v23, 0
    v_mov_b32 v24, 0
    v_mov_b32 v25, 0
    v_mov_b32 v26, 0
    v_mov_b32 v27, 0
    v_mov_b32 v28, 0
    v_mov_b32 v29, 0
    v_mov_b32 v30, 0
    v_mov_b32 v31, 0
    v_mov_b32 v32, 0
    v_mov_b32 v33, 0
    v_mov_b32 v34, 0
    v_mov_b32 v35, 0
    v_mov_b32 v36, 0
    v_mov_b32 v37, 0
    v_mov_b32 v38, 0
    v_mov_b32 v39, 0
    v_mov_b32 v40, 0
    v_mov_b32 v41, 0
    v_mov_b32 v42, 0
    v_mov_b32 v43, 0
    v_mov_b32 v44, 0
    v_mov_b32 v45, 0
    v_mov_b32 v46, 0
    v_mov_b32 v47, 0
    v_mov_b32 v48, 0
    v_mov_b32 v49, 0
    v_mov_b32 v50, 0
    v_mov_b32 v51, 0
    v_mov_b32 v52, 0
    v_mov_b32 v53, 0
    v_mov_b32 v54, 0
    v_mov_b32 v55, 0
    v_mov_b32 v56, 0
    v_mov_b32 v57, 0
    v_mov_b32 v58, 0
    v_mov_b32 v59, 0
    v_mov_b32 v60, 0
    v_mov_b32 v61, 0
    v_mov_b32 v62, 0
    v_mov_b32 v63, 0
    v_mov_b32 v64, 0
    v_mov_b32 v65, 0
    v_mov_b32 v66, 0
    v_mov_b32 v67, 0
    v_mov_b32 v68, 0
    v_mov_b32 v69, 0
    v_mov_b32 v70, 0
    v_mov_b32 v71, 0
    v_mov_b32 v72, 0
    v_mov_b32 v73, 0
    v_mov_b32 v74, 0
    v_mov_b32 v75, 0
    v_mov_b32 v76, 0
    v_mov_b32 v77, 0
    v_mov_b32 v78, 0
    v_mov_b32 v79, 0
    v_mov_b32 v80, 0
    v_mov_b32 v81, 0
    v_mov_b32 v82, 0
    v_mov_b32 v83, 0
    s_mov_b32 s36, 0
    s_lshl_b32 s26, s24, 8
    s_add_u32 s26, s26, 147968
    s_mul_i32 s27, s25, 320
    s_add_u32 s27, s27, 148992
    s_cmp_ge_u32 s22, 8
    s_cbranch_scc1 L1_preV
L1_preQ:
    v_lshl_add_u32 v159, v84, 2, s26
    v_mul_u32_u24 v160, 80, v85
    v_add_u32 v160, s27, v160
    s_cmp_lt_u32 s22, 4
    s_cselect_b32 s31, 0x3ea52b5c, 1.0
    s_cselect_b32 s28, 0x500000, 0
    s_cselect_b32 s29, 0, 1
    s_lshl_b32 s34, 81920, s29
    s_lshl_b32 s35, 1280, s29
    s_and_b32 s29, s22, 3
    s_lshl_b32 s29, s29, 3
    s_lshl_b32 s30, s25, 2
    s_add_u32 s29, s29, s30
    s_mul_i32 s29, s29, s34
    s_add_u32 s28, s28, s29
    s_lshl_b32 s29, s21, 2
    s_lshl_b32 s30, s24, 1
    s_add_u32 s29, s29, s30
    s_mul_i32 s29, s29, s35
    s_add_u32 s28, s28, s29
    s_add_u32 s29, s28, s35
    v_mul_lo_u32 v87, s34, v85
    v_and_b32 v86, 8, v84
    v_add_u32 v86, v86, v84
    v_lshl_add_u32 v163, v84, 4, v87
    v_lshl_add_u32 v162, v86, 4, v87
    s_barrier
    ds_read_b128 v[84:87], v156 offset:0
    ds_read_b64_tr_b16 v[100:101], v158 offset:0
    ds_read_b64_tr_b16 v[102:103], v158 offset:1280
    ds_read_b64_tr_b16 v[104:105], v158 offset:8
    ds_read_b64_tr_b16 v[106:107], v158 offset:1288
    ds_read_b64_tr_b16 v[108:109], v158 offset:16
    ds_read_b64_tr_b16 v[110:111], v158 offset:1296
    ds_read_b64_tr_b16 v[112:113], v158 offset:24
    ds_read_b64_tr_b16 v[114:115], v158 offset:1304
    ds_read_b64_tr_b16 v[116:117], v158 offset:32
    ds_read_b64_tr_b16 v[118:119], v158 offset:1312
    ds_read_b128 v[88:91], v156 offset:2048
    ds_read_b128 v[92:95], v156 offset:4096
    ds_read_b128 v[96:99], v156 offset:6144
.p2align 6
L1_loopQ:
    s_waitcnt lgkmcnt(0)
    v_mfma_f32_16x16x32_bf16 v[4:7], v[100:103], v[84:87], v[4:7]
    ds_read_b128 v[120:123], v157 offset:0
    v_mfma_f32_16x16x32_bf16 v[8:11], v[104:107], v[84:87], v[8:11]
    ds_read_b64_tr_b16 v[136:137], v158 offset:2560
    v_mfma_f32_16x16x32_bf16 v[12:15], v[108:111], v[84:87], v[12:15]
    ds_read_b64_tr_b16 v[138:139], v158 offset:3840
    v_mfma_f32_16x16x32_bf16 v[16:19], v[112:115], v[84:87], v[16:19]
    ds_read_b64_tr_b16 v[140:141], v158 offset:2568
    v_mfma_f32_16x16x32_bf16 v[20:23], v[116:119], v[84:87], v[20:23]
    ds_read_b64_tr_b16 v[142:143], v158 offset:3848
    v_mfma_f32_16x16x32_bf16 v[24:27], v[100:103], v[88:91], v[24:27]
    ds_read_b64_tr_b16 v[144:145], v158 offset:2576
    v_mfma_f32_16x16x32_bf16 v[28:31], v[104:107], v[88:91], v[28:31]
    ds_read_b64_tr_b16 v[146:147], v158 offset:3856
    v_mfma_f32_16x16x32_bf16 v[32:35], v[108:111], v[88:91], v[32:35]
    ds_read_b64_tr_b16 v[148:149], v158 offset:2584
    v_mfma_f32_16x16x32_bf16 v[36:39], v[112:115], v[88:91], v[36:39]
    ds_read_b64_tr_b16 v[150:151], v158 offset:3864
    v_mfma_f32_16x16x32_bf16 v[40:43], v[116:119], v[88:91], v[40:43]
    ds_read_b64_tr_b16 v[152:153], v158 offset:2592
    v_mfma_f32_16x16x32_bf16 v[44:47], v[100:103], v[92:95], v[44:47]
    ds_read_b64_tr_b16 v[154:155], v158 offset:3872
    v_mfma_f32_16x16x32_bf16 v[48:51], v[104:107], v[92:95], v[48:51]
    ds_read_b128 v[124:127], v157 offset:2048
    v_mfma_f32_16x16x32_bf16 v[52:55], v[108:111], v[92:95], v[52:55]
    ds_read_b128 v[128:131], v157 offset:4096
    v_mfma_f32_16x16x32_bf16 v[56:59], v[112:115], v[92:95], v[56:59]
    ds_read_b128 v[132:135], v157 offset:6144
    v_mfma_f32_16x16x32_bf16 v[60:63], v[116:119], v[92:95], v[60:63]
    s_add_u32 s36, s36, 1
    v_mfma_f32_16x16x32_bf16 v[64:67], v[100:103], v[96:99], v[64:67]
    s_and_b32 s37, s36, 3
    v_mfma_f32_16x16x32_bf16 v[68:71], v[104:107], v[96:99], v[68:71]
    s_cselect_b32 s37, s39, 4294856320
    v_mfma_f32_16x16x32_bf16 v[72:75], v[108:111], v[96:99], v[72:75]
    v_add_u32 v156, s37, v156
    v_mfma_f32_16x16x32_bf16 v[76:79], v[112:115], v[96:99], v[76:79]
    v_add_u32 v158, s37, v158
    v_mfma_f32_16x16x32_bf16 v[80:83], v[116:119], v[96:99], v[80:83]
    v_add_u32 v157, s37, v157
    s_waitcnt lgkmcnt(0)
    v_mfma_f32_16x16x32_bf16 v[4:7], v[136:139], v[120:123], v[4:7]
    s_barrier
    v_mfma_f32_16x16x32_bf16 v[8:11], v[140:143], v[120:123], v[8:11]
    ds_read_b128 v[84:87], v156 offset:0
    v_mfma_f32_16x16x32_bf16 v[12:15], v[144:147], v[120:123], v[12:15]
    ds_read_b64_tr_b16 v[100:101], v158 offset:0
    v_mfma_f32_16x16x32_bf16 v[16:19], v[148:151], v[120:123], v[16:19]
    ds_read_b64_tr_b16 v[102:103], v158 offset:1280
    v_mfma_f32_16x16x32_bf16 v[20:23], v[152:155], v[120:123], v[20:23]
    ds_read_b64_tr_b16 v[104:105], v158 offset:8
    v_mfma_f32_16x16x32_bf16 v[24:27], v[136:139], v[124:127], v[24:27]
    ds_read_b64_tr_b16 v[106:107], v158 offset:1288
    v_mfma_f32_16x16x32_bf16 v[28:31], v[140:143], v[124:127], v[28:31]
    ds_read_b64_tr_b16 v[108:109], v158 offset:16
    v_mfma_f32_16x16x32_bf16 v[32:35], v[144:147], v[124:127], v[32:35]
    ds_read_b64_tr_b16 v[110:111], v158 offset:1296
    v_mfma_f32_16x16x32_bf16 v[36:39], v[148:151], v[124:127], v[36:39]
    ds_read_b64_tr_b16 v[112:113], v158 offset:24
    v_mfma_f32_16x16x32_bf16 v[40:43], v[152:155], v[124:127], v[40:43]
    ds_read_b64_tr_b16 v[114:115], v158 offset:1304
    v_mfma_f32_16x16x32_bf16 v[44:47], v[136:139], v[128:131], v[44:47]
    ds_read_b64_tr_b16 v[116:117], v158 offset:32
    v_mfma_f32_16x16x32_bf16 v[48:51], v[140:143], v[128:131], v[48:51]
    ds_read_b64_tr_b16 v[118:119], v158 offset:1312
    v_mfma_f32_16x16x32_bf16 v[52:55], v[144:147], v[128:131], v[52:55]
    ds_read_b128 v[88:91], v156 offset:2048
    v_mfma_f32_16x16x32_bf16 v[56:59], v[148:151], v[128:131], v[56:59]
    ds_read_b128 v[92:95], v156 offset:4096
    v_mfma_f32_16x16x32_bf16 v[60:63], v[152:155], v[128:131], v[60:63]
    ds_read_b128 v[96:99], v156 offset:6144
    v_mfma_f32_16x16x32_bf16 v[64:67], v[136:139], v[132:135], v[64:67]
    v_mfma_f32_16x16x32_bf16 v[68:71], v[140:143], v[132:135], v[68:71]
    v_mfma_f32_16x16x32_bf16 v[72:75], v[144:147], v[132:135], v[72:75]
    v_mfma_f32_16x16x32_bf16 v[76:79], v[148:151], v[132:135], v[76:79]
    v_mfma_f32_16x16x32_bf16 v[80:83], v[152:155], v[132:135], v[80:83]
    s_cmp_lt_u32 s36, 10
    s_cbranch_scc1 L1_loopQ
    s_waitcnt lgkmcnt(0)
    s_barrier
    ds_read2st64_b32 v[124:125], v159 offset0:0 offset1:2
    v_add_u32 v159, 64, v159
    ds_read2st64_b32 v[126:127], v159 offset0:0 offset1:2
    v_add_u32 v159, 64, v159
    ds_read2st64_b32 v[128:129], v159 offset0:0 offset1:2
    v_add_u32 v159, 64, v159
    ds_read2st64_b32 v[130:131], v159 offset0:0 offset1:2
    ds_read_b128 v[132:135], v160 offset:0
    ds_read_b128 v[136:139], v160 offset:16
    ds_read_b128 v[140:143], v160 offset:32
    ds_read_b128 v[144:147], v160 offset:48
    ds_read_b128 v[148:151], v160 offset:64
    s_waitcnt vmcnt(0) lgkmcnt(0)
    v_mul_f32 v125, s31, v125
    v_mul_f32 v127, s31, v127
    v_mul_f32 v129, s31, v129
    v_mul_f32 v131, s31, v131
    v_pk_fma_f32 v[4:5], v[124:125], v[132:133], v[4:5] op_sel:[0,0,0] op_sel_hi:[0,1,1] neg_lo:[1,0,0] neg_hi:[1,0,0]
    v_pk_fma_f32 v[6:7], v[124:125], v[134:135], v[6:7] op_sel:[0,0,0] op_sel_hi:[0,1,1] neg_lo:[1,0,0] neg_hi:[1,0,0]
    v_pk_fma_f32 v[8:9], v[124:125], v[136:137], v[8:9] op_sel:[0,0,0] op_sel_hi:[0,1,1] neg_lo:[1,0,0] neg_hi:[1,0,0]
    v_pk_fma_f32 v[10:11], v[124:125], v[138:139], v[10:11] op_sel:[0,0,0] op_sel_hi:[0,1,1] neg_lo:[1,0,0] neg_hi:[1,0,0]
    v_pk_fma_f32 v[12:13], v[124:125], v[140:141], v[12:13] op_sel:[0,0,0] op_sel_hi:[0,1,1] neg_lo:[1,0,0] neg_hi:[1,0,0]
    v_pk_fma_f32 v[14:15], v[124:125], v[142:143], v[14:15] op_sel:[0,0,0] op_sel_hi:[0,1,1] neg_lo:[1,0,0] neg_hi:[1,0,0]
    v_pk_fma_f32 v[16:17], v[124:125], v[144:145], v[16:17] op_sel:[0,0,0] op_sel_hi:[0,1,1] neg_lo:[1,0,0] neg_hi:[1,0,0]
    v_pk_fma_f32 v[18:19], v[124:125], v[146:147], v[18:19] op_sel:[0,0,0] op_sel_hi:[0,1,1] neg_lo:[1,0,0] neg_hi:[1,0,0]
    v_pk_fma_f32 v[20:21], v[124:125], v[148:149], v[20:21] op_sel:[0,0,0] op_sel_hi:[0,1,1] neg_lo:[1,0,0] neg_hi:[1,0,0]
    v_pk_fma_f32 v[22:23], v[124:125], v[150:151], v[22:23] op_sel:[0,0,0] op_sel_hi:[0,1,1] neg_lo:[1,0,0] neg_hi:[1,0,0]
    v_pk_mul_f32 v[4:5], v[124:125], v[4:5] op_sel:[1,0] op_sel_hi:[1,1]
    v_pk_mul_f32 v[6:7], v[124:125], v[6:7] op_sel:[1,0] op_sel_hi:[1,1]
    v_pk_mul_f32 v[8:9], v[124:125], v[8:9] op_sel:[1,0] op_sel_hi:[1,1]
    v_pk_mul_f32 v[10:11], v[124:125], v[10:11] op_sel:[1,0] op_sel_hi:[1,1]
    v_pk_mul_f32 v[12:13], v[124:125], v[12:13] op_sel:[1,0] op_sel_hi:[1,1]
    v_pk_mul_f32 v[14:15], v[124:125], v[14:15] op_sel:[1,0] op_sel_hi:[1,1]
    v_pk_mul_f32 v[16:17], v[124:125], v[16:17] op_sel:[1,0] op_sel_hi:[1,1]
    v_pk_mul_f32 v[18:19], v[124:125], v[18:19] op_sel:[1,0] op_sel_hi:[1,1]
    v_pk_mul_f32 v[20:21], v[124:125], v[20:21] op_sel:[1,0] op_sel_hi:[1,1]
    v_pk_mul_f32 v[22:23], v[124:125], v[22:23] op_sel:[1,0] op_sel_hi:[1,1]
    v_cvt_pk_bf16_f32 v84, v4, v5
    v_cvt_pk_bf16_f32 v85, v6, v7
    v_cvt_pk_bf16_f32 v86, v8, v9
    v_cvt_pk_bf16_f32 v87, v10, v11
    v_cvt_pk_bf16_f32 v88, v12, v13
    v_cvt_pk_bf16_f32 v89, v14, v15
    v_cvt_pk_bf16_f32 v90, v16, v17
    v_cvt_pk_bf16_f32 v91, v18, v19
    v_cvt_pk_bf16_f32 v116, v20, v21
    v_cvt_pk_bf16_f32 v117, v22, v23
    buffer_store_dwordx4 v[84:87], v162, s[16:19], s28 offen offset:0 sc1
    buffer_store_dwordx4 v[88:91], v162, s[16:19], s28 offen offset:512 sc1
    v_pk_fma_f32 v[24:25], v[126:127], v[132:133], v[24:25] op_sel:[0,0,0] op_sel_hi:[0,1,1] neg_lo:[1,0,0] neg_hi:[1,0,0]
    v_pk_fma_f32 v[26:27], v[126:127], v[134:135], v[26:27] op_sel:[0,0,0] op_sel_hi:[0,1,1] neg_lo:[1,0,0] neg_hi:[1,0,0]
    v_pk_fma_f32 v[28:29], v[126:127], v[136:137], v[28:29] op_sel:[0,0,0] op_sel_hi:[0,1,1] neg_lo:[1,0,0] neg_hi:[1,0,0]
    v_pk_fma_f32 v[30:31], v[126:127], v[138:139], v[30:31] op_sel:[0,0,0] op_sel_hi:[0,1,1] neg_lo:[1,0,0] neg_hi:[1,0,0]
    v_pk_fma_f32 v[32:33], v[126:127], v[140:141], v[32:33] op_sel:[0,0,0] op_sel_hi:[0,1,1] neg_lo:[1,0,0] neg_hi:[1,0,0]
    v_pk_fma_f32 v[34:35], v[126:127], v[142:143], v[34:35] op_sel:[0,0,0] op_sel_hi:[0,1,1] neg_lo:[1,0,0] neg_hi:[1,0,0]
    v_pk_fma_f32 v[36:37], v[126:127], v[144:145], v[36:37] op_sel:[0,0,0] op_sel_hi:[0,1,1] neg_lo:[1,0,0] neg_hi:[1,0,0]
    v_pk_fma_f32 v[38:39], v[126:127], v[146:147], v[38:39] op_sel:[0,0,0] op_sel_hi:[0,1,1] neg_lo:[1,0,0] neg_hi:[1,0,0]
    v_pk_fma_f32 v[40:41], v[126:127], v[148:149], v[40:41] op_sel:[0,0,0] op_sel_hi:[0,1,1] neg_lo:[1,0,0] neg_hi:[1,0,0]
    v_pk_fma_f32 v[42:43], v[126:127], v[150:151], v[42:43] op_sel:[0,0,0] op_sel_hi:[0,1,1] neg_lo:[1,0,0] neg_hi:[1,0,0]
    v_pk_mul_f32 v[24:25], v[126:127], v[24:25] op_sel:[1,0] op_sel_hi:[1,1]
    v_pk_mul_f32 v[26:27], v[126:127], v[26:27] op_sel:[1,0] op_sel_hi:[1,1]
    v_pk_mul_f32 v[28:29], v[126:127], v[28:29] op_sel:[1,0] op_sel_hi:[1,1]
    v_pk_mul_f32 v[30:31], v[126:127], v[30:31] op_sel:[1,0] op_sel_hi:[1,1]
    v_pk_mul_f32 v[32:33], v[126:127], v[32:33] op_sel:[1,0] op_sel_hi:[1,1]
    v_pk_mul_f32 v[34:35], v[126:127], v[34:35] op_sel:[1,0] op_sel_hi:[1,1]
    v_pk_mul_f32 v[36:37], v[126:127], v[36:37] op_sel:[1,0] op_sel_hi:[1,1]
    v_pk_mul_f32 v[38:39], v[126:127], v[38:39] op_sel:[1,0] op_sel_hi:[1,1]
    v_pk_mul_f32 v[40:41], v[126:127], v[40:41] op_sel:[1,0] op_sel_hi:[1,1]
    v_pk_mul_f32 v[42:43], v[126:127], v[42:43] op_sel:[1,0] op_sel_hi:[1,1]
    v_cvt_pk_bf16_f32 v92, v24, v25
    v_cvt_pk_bf16_f32 v93, v26, v27
    v_cvt_pk_bf16_f32 v94, v28, v29
    v_cvt_pk_bf16_f32 v95, v30, v31
    v_cvt_pk_bf16_f32 v96, v32, v33
    v_cvt_pk_bf16_f32 v97, v34, v35
    v_cvt_pk_bf16_f32 v98, v36, v37
    v_cvt_pk_bf16_f32 v99, v38, v39
    v_cvt_pk_bf16_f32 v118, v40, v41
    v_cvt_pk_bf16_f32 v119, v42, v43
    buffer_store_dwordx4 v[92:95], v162, s[16:19], s28 offen offset:128 sc1
    buffer_store_dwordx4 v[96:99], v162, s[16:19], s28 offen offset:640 sc1
    buffer_store_dwordx4 v[116:119], v163, s[16:19], s28 offen offset:1024 sc1
    v_pk_fma_f32 v[44:45], v[128:129], v[132:133], v[44:45] op_sel:[0,0,0] op_sel_hi:[0,1,1] neg_lo:[1,0,0] neg_hi:[1,0,0]
    v_pk_fma_f32 v[46:47], v[128:129], v[134:135], v[46:47] op_sel:[0,0,0] op_sel_hi:[0,1,1] neg_lo:[1,0,0] neg_hi:[1,0,0]
    v_pk_fma_f32 v[48:49], v[128:129], v[136:137], v[48:49] op_sel:[0,0,0] op_sel_hi:[0,1,1] neg_lo:[1,0,0] neg_hi:[1,0,0]
    v_pk_fma_f32 v[50:51], v[128:129], v[138:139], v[50:51] op_sel:[0,0,0] op_sel_hi:[0,1,1] neg_lo:[1,0,0] neg_hi:[1,0,0]
    v_pk_fma_f32 v[52:53], v[128:129], v[140:141], v[52:53] op_sel:[0,0,0] op_sel_hi:[0,1,1] neg_lo:[1,0,0] neg_hi:[1,0,0]
    v_pk_fma_f32 v[54:55], v[128:129], v[142:143], v[54:55] op_sel:[0,0,0] op_sel_hi:[0,1,1] neg_lo:[1,0,0] neg_hi:[1,0,0]
    v_pk_fma_f32 v[56:57], v[128:129], v[144:145], v[56:57] op_sel:[0,0,0] op_sel_hi:[0,1,1] neg_lo:[1,0,0] neg_hi:[1,0,0]
    v_pk_fma_f32 v[58:59], v[128:129], v[146:147], v[58:59] op_sel:[0,0,0] op_sel_hi:[0,1,1] neg_lo:[1,0,0] neg_hi:[1,0,0]
    v_pk_fma_f32 v[60:61], v[128:129], v[148:149], v[60:61] op_sel:[0,0,0] op_sel_hi:[0,1,1] neg_lo:[1,0,0] neg_hi:[1,0,0]
    v_pk_fma_f32 v[62:63], v[128:129], v[150:151], v[62:63] op_sel:[0,0,0] op_sel_hi:[0,1,1] neg_lo:[1,0,0] neg_hi:[1,0,0]
    v_pk_mul_f32 v[44:45], v[128:129], v[44:45] op_sel:[1,0] op_sel_hi:[1,1]
    v_pk_mul_f32 v[46:47], v[128:129], v[46:47] op_sel:[1,0] op_sel_hi:[1,1]
    v_pk_mul_f32 v[48:49], v[128:129], v[48:49] op_sel:[1,0] op_sel_hi:[1,1]
    v_pk_mul_f32 v[50:51], v[128:129], v[50:51] op_sel:[1,0] op_sel_hi:[1,1]
    v_pk_mul_f32 v[52:53], v[128:129], v[52:53] op_sel:[1,0] op_sel_hi:[1,1]
    v_pk_mul_f32 v[54:55], v[128:129], v[54:55] op_sel:[1,0] op_sel_hi:[1,1]
    v_pk_mul_f32 v[56:57], v[128:129], v[56:57] op_sel:[1,0] op_sel_hi:[1,1]
    v_pk_mul_f32 v[58:59], v[128:129], v[58:59] op_sel:[1,0] op_sel_hi:[1,1]
    v_pk_mul_f32 v[60:61], v[128:129], v[60:61] op_sel:[1,0] op_sel_hi:[1,1]
    v_pk_mul_f32 v[62:63], v[128:129], v[62:63] op_sel:[1,0] op_sel_hi:[1,1]
    v_cvt_pk_bf16_f32 v100, v44, v45
    v_cvt_pk_bf16_f32 v101, v46, v47
    v_cvt_pk_bf16_f32 v102, v48, v49
    v_cvt_pk_bf16_f32 v103, v50, v51
    v_cvt_pk_bf16_f32 v104, v52, v53
    v_cvt_pk_bf16_f32 v105, v54, v55
    v_cvt_pk_bf16_f32 v106, v56, v57
    v_cvt_pk_bf16_f32 v107, v58, v59
    v_cvt_pk_bf16_f32 v120, v60, v61
    v_cvt_pk_bf16_f32 v121, v62, v63
    buffer_store_dwordx4 v[100:103], v162, s[16:19], s29 offen offset:0 sc1
    buffer_store_dwordx4 v[104:107], v162, s[16:19], s29 offen offset:512 sc1
    v_pk_fma_f32 v[64:65], v[130:131], v[132:133], v[64:65] op_sel:[0,0,0] op_sel_hi:[0,1,1] neg_lo:[1,0,0] neg_hi:[1,0,0]
    v_pk_fma_f32 v[66:67], v[130:131], v[134:135], v[66:67] op_sel:[0,0,0] op_sel_hi:[0,1,1] neg_lo:[1,0,0] neg_hi:[1,0,0]
    v_pk_fma_f32 v[68:69], v[130:131], v[136:137], v[68:69] op_sel:[0,0,0] op_sel_hi:[0,1,1] neg_lo:[1,0,0] neg_hi:[1,0,0]
    v_pk_fma_f32 v[70:71], v[130:131], v[138:139], v[70:71] op_sel:[0,0,0] op_sel_hi:[0,1,1] neg_lo:[1,0,0] neg_hi:[1,0,0]
    v_pk_fma_f32 v[72:73], v[130:131], v[140:141], v[72:73] op_sel:[0,0,0] op_sel_hi:[0,1,1] neg_lo:[1,0,0] neg_hi:[1,0,0]
    v_pk_fma_f32 v[74:75], v[130:131], v[142:143], v[74:75] op_sel:[0,0,0] op_sel_hi:[0,1,1] neg_lo:[1,0,0] neg_hi:[1,0,0]
    v_pk_fma_f32 v[76:77], v[130:131], v[144:145], v[76:77] op_sel:[0,0,0] op_sel_hi:[0,1,1] neg_lo:[1,0,0] neg_hi:[1,0,0]
    v_pk_fma_f32 v[78:79], v[130:131], v[146:147], v[78:79] op_sel:[0,0,0] op_sel_hi:[0,1,1] neg_lo:[1,0,0] neg_hi:[1,0,0]
    v_pk_fma_f32 v[80:81], v[130:131], v[148:149], v[80:81] op_sel:[0,0,0] op_sel_hi:[0,1,1] neg_lo:[1,0,0] neg_hi:[1,0,0]
    v_pk_fma_f32 v[82:83], v[130:131], v[150:151], v[82:83] op_sel:[0,0,0] op_sel_hi:[0,1,1] neg_lo:[1,0,0] neg_hi:[1,0,0]
    v_pk_mul_f32 v[64:65], v[130:131], v[64:65] op_sel:[1,0] op_sel_hi:[1,1]
    v_pk_mul_f32 v[66:67], v[130:131], v[66:67] op_sel:[1,0] op_sel_hi:[1,1]
    v_pk_mul_f32 v[68:69], v[130:131], v[68:69] op_sel:[1,0] op_sel_hi:[1,1]
    v_pk_mul_f32 v[70:71], v[130:131], v[70:71] op_sel:[1,0] op_sel_hi:[1,1]
    v_pk_mul_f32 v[72:73], v[130:131], v[72:73] op_sel:[1,0] op_sel_hi:[1,1]
    v_pk_mul_f32 v[74:75], v[130:131], v[74:75] op_sel:[1,0] op_sel_hi:[1,1]
    v_pk_mul_f32 v[76:77], v[130:131], v[76:77] op_sel:[1,0] op_sel_hi:[1,1]
    v_pk_mul_f32 v[78:79], v[130:131], v[78:79] op_sel:[1,0] op_sel_hi:[1,1]
    v_pk_mul_f32 v[80:81], v[130:131], v[80:81] op_sel:[1,0] op_sel_hi:[1,1]
    v_pk_mul_f32 v[82:83], v[130:131], v[82:83] op_sel:[1,0] op_sel_hi:[1,1]
    v_cvt_pk_bf16_f32 v108, v64, v65
    v_cvt_pk_bf16_f32 v109, v66, v67
    v_cvt_pk_bf16_f32 v110, v68, v69
    v_cvt_pk_bf16_f32 v111, v70, v71
    v_cvt_pk_bf16_f32 v112, v72, v73
    v_cvt_pk_bf16_f32 v113, v74, v75
    v_cvt_pk_bf16_f32 v114, v76, v77
    v_cvt_pk_bf16_f32 v115, v78, v79
    v_cvt_pk_bf16_f32 v122, v80, v81
    v_cvt_pk_bf16_f32 v123, v82, v83
    buffer_store_dwordx4 v[108:111], v162, s[16:19], s29 offen offset:128 sc1
    buffer_store_dwordx4 v[112:115], v162, s[16:19], s29 offen offset:640 sc1
    buffer_store_dwordx4 v[120:123], v163, s[16:19], s29 offen offset:1024 sc1
    s_endpgm
L1_preV:
    v_lshl_add_u32 v159, v85, 4, s26
    v_lshrrev_b32 v160, 2, v84
    v_mul_u32_u24 v160, 80, v160
    v_and_b32 v87, 3, v0
    v_lshl_add_u32 v160, v87, 2, v160
    v_add_u32 v160, s27, v160
    s_and_b32 s29, s22, 3
    s_lshl_b32 s29, s29, 3
    s_lshl_b32 s30, s25, 2
    s_add_u32 s29, s29, s30
    s_mul_i32 s28, s29, 163840
    s_lshl_b32 s29, s21, 2
    s_lshl_b32 s30, s24, 1
    s_add_u32 s29, s29, s30
    s_mul_i32 s29, s29, 2560
    s_add_u32 s28, s28, s29
    s_add_u32 s28, s28, 1280
    s_mov_b32 s34, 163840
    v_lshrrev_b32 v86, 2, v84
    v_mul_lo_u32 v84, s34, v86
    v_and_b32 v86, 3, v0
    v_lshl_add_u32 v84, v86, 4, v84
    v_add_u32 v86, 0, v85
    v_and_b32 v86, 3, v86
    v_lshl_add_u32 v162, v86, 6, v84
    v_add_u32 v86, 1, v85
    v_and_b32 v86, 3, v86
    v_lshl_add_u32 v163, v86, 6, v84
    v_add_u32 v86, 2, v85
    v_and_b32 v86, 3, v86
    v_lshl_add_u32 v164, v86, 6, v84
    v_add_u32 v86, 3, v85
    v_and_b32 v86, 3, v86
    v_lshl_add_u32 v165, v86, 6, v84
    s_barrier
    ds_read_b128 v[84:87], v156 offset:0
    ds_read_b64_tr_b16 v[100:101], v158 offset:0
    ds_read_b64_tr_b16 v[102:103], v158 offset:1280
    ds_read_b64_tr_b16 v[104:105], v158 offset:8
    ds_read_b64_tr_b16 v[106:107], v158 offset:1288
    ds_read_b64_tr_b16 v[108:109], v158 offset:16
    ds_read_b64_tr_b16 v[110:111], v158 offset:1296
    ds_read_b64_tr_b16 v[112:113], v158 offset:24
    ds_read_b64_tr_b16 v[114:115], v158 offset:1304
    ds_read_b64_tr_b16 v[116:117], v158 offset:32
    ds_read_b64_tr_b16 v[118:119], v158 offset:1312
    ds_read_b128 v[88:91], v156 offset:2048
    ds_read_b128 v[92:95], v156 offset:4096
    ds_read_b128 v[96:99], v156 offset:6144
.p2align 6
L1_loopV:
    s_waitcnt lgkmcnt(0)
    v_mfma_f32_16x16x32_bf16 v[4:7], v[84:87], v[100:103], v[4:7]
    ds_read_b128 v[120:123], v157 offset:0
    v_mfma_f32_16x16x32_bf16 v[8:11], v[84:87], v[104:107], v[8:11]
    ds_read_b64_tr_b16 v[136:137], v158 offset:2560
    v_mfma_f32_16x16x32_bf16 v[12:15], v[84:87], v[108:111], v[12:15]
    ds_read_b64_tr_b16 v[138:139], v158 offset:3840
    v_mfma_f32_16x16x32_bf16 v[16:19], v[84:87], v[112:115], v[16:19]
    ds_read_b64_tr_b16 v[140:141], v158 offset:2568
    v_mfma_f32_16x16x32_bf16 v[20:23], v[84:87], v[116:119], v[20:23]
    ds_read_b64_tr_b16 v[142:143], v158 offset:3848
    v_mfma_f32_16x16x32_bf16 v[24:27], v[88:91], v[100:103], v[24:27]
    ds_read_b64_tr_b16 v[144:145], v158 offset:2576
    v_mfma_f32_16x16x32_bf16 v[28:31], v[88:91], v[104:107], v[28:31]
    ds_read_b64_tr_b16 v[146:147], v158 offset:3856
    v_mfma_f32_16x16x32_bf16 v[32:35], v[88:91], v[108:111], v[32:35]
    ds_read_b64_tr_b16 v[148:149], v158 offset:2584
    v_mfma_f32_16x16x32_bf16 v[36:39], v[88:91], v[112:115], v[36:39]
    ds_read_b64_tr_b16 v[150:151], v158 offset:3864
    v_mfma_f32_16x16x32_bf16 v[40:43], v[88:91], v[116:119], v[40:43]
    ds_read_b64_tr_b16 v[152:153], v158 offset:2592
    v_mfma_f32_16x16x32_bf16 v[44:47], v[92:95], v[100:103], v[44:47]
    ds_read_b64_tr_b16 v[154:155], v158 offset:3872
    v_mfma_f32_16x16x32_bf16 v[48:51], v[92:95], v[104:107], v[48:51]
    ds_read_b128 v[124:127], v157 offset:2048
    v_mfma_f32_16x16x32_bf16 v[52:55], v[92:95], v[108:111], v[52:55]
    ds_read_b128 v[128:131], v157 offset:4096
    v_mfma_f32_16x16x32_bf16 v[56:59], v[92:95], v[112:115], v[56:59]
    ds_read_b128 v[132:135], v157 offset:6144
    v_mfma_f32_16x16x32_bf16 v[60:63], v[92:95], v[116:119], v[60:63]
    s_add_u32 s36, s36, 1
    v_mfma_f32_16x16x32_bf16 v[64:67], v[96:99], v[100:103], v[64:67]
    s_and_b32 s37, s36, 3
    v_mfma_f32_16x16x32_bf16 v[68:71], v[96:99], v[104:107], v[68:71]
    s_cselect_b32 s37, s39, 4294856320
    v_mfma_f32_16x16x32_bf16 v[72:75], v[96:99], v[108:111], v[72:75]
    v_add_u32 v156, s37, v156
    v_mfma_f32_16x16x32_bf16 v[76:79], v[96:99], v[112:115], v[76:79]
    v_add_u32 v158, s37, v158
    v_mfma_f32_16x16x32_bf16 v[80:83], v[96:99], v[116:119], v[80:83]
    v_add_u32 v157, s37, v157
    s_waitcnt lgkmcnt(0)
    v_mfma_f32_16x16x32_bf16 v[4:7], v[120:123], v[136:139], v[4:7]
    s_barrier
    v_mfma_f32_16x16x32_bf16 v[8:11], v[120:123], v[140:143], v[8:11]
    ds_read_b128 v[84:87], v156 offset:0
    v_mfma_f32_16x16x32_bf16 v[12:15], v[120:123], v[144:147], v[12:15]
    ds_read_b64_tr_b16 v[100:101], v158 offset:0
    v_mfma_f32_16x16x32_bf16 v[16:19], v[120:123], v[148:151], v[16:19]
    ds_read_b64_tr_b16 v[102:103], v158 offset:1280
    v_mfma_f32_16x16x32_bf16 v[20:23], v[120:123], v[152:155], v[20:23]
    ds_read_b64_tr_b16 v[104:105], v158 offset:8
    v_mfma_f32_16x16x32_bf16 v[24:27], v[124:127], v[136:139], v[24:27]
    ds_read_b64_tr_b16 v[106:107], v158 offset:1288
    v_mfma_f32_16x16x32_bf16 v[28:31], v[124:127], v[140:143], v[28:31]
    ds_read_b64_tr_b16 v[108:109], v158 offset:16
    v_mfma_f32_16x16x32_bf16 v[32:35], v[124:127], v[144:147], v[32:35]
    ds_read_b64_tr_b16 v[110:111], v158 offset:1296
    v_mfma_f32_16x16x32_bf16 v[36:39], v[124:127], v[148:151], v[36:39]
    ds_read_b64_tr_b16 v[112:113], v158 offset:24
    v_mfma_f32_16x16x32_bf16 v[40:43], v[124:127], v[152:155], v[40:43]
    ds_read_b64_tr_b16 v[114:115], v158 offset:1304
    v_mfma_f32_16x16x32_bf16 v[44:47], v[128:131], v[136:139], v[44:47]
    ds_read_b64_tr_b16 v[116:117], v158 offset:32
    v_mfma_f32_16x16x32_bf16 v[48:51], v[128:131], v[140:143], v[48:51]
    ds_read_b64_tr_b16 v[118:119], v158 offset:1312
    v_mfma_f32_16x16x32_bf16 v[52:55], v[128:131], v[144:147], v[52:55]
    ds_read_b128 v[88:91], v156 offset:2048
    v_mfma_f32_16x16x32_bf16 v[56:59], v[128:131], v[148:151], v[56:59]
    ds_read_b128 v[92:95], v156 offset:4096
    v_mfma_f32_16x16x32_bf16 v[60:63], v[128:131], v[152:155], v[60:63]
    ds_read_b128 v[96:99], v156 offset:6144
    v_mfma_f32_16x16x32_bf16 v[64:67], v[132:135], v[136:139], v[64:67]
    v_mfma_f32_16x16x32_bf16 v[68:71], v[132:135], v[140:143], v[68:71]
    v_mfma_f32_16x16x32_bf16 v[72:75], v[132:135], v[144:147], v[72:75]
    v_mfma_f32_16x16x32_bf16 v[76:79], v[132:135], v[148:151], v[76:79]
    v_mfma_f32_16x16x32_bf16 v[80:83], v[132:135], v[152:155], v[80:83]
    s_cmp_lt_u32 s36, 10
    s_cbranch_scc1 L1_loopV
    s_waitcnt lgkmcnt(0)
    s_barrier
    ds_read_b128 v[124:127], v159 offset:0
    ds_read_b128 v[128:131], v159 offset:512
    ds_read_b128 v[132:135], v159 offset:64
    ds_read_b128 v[136:139], v159 offset:576
    ds_read_b128 v[140:143], v159 offset:128
    ds_read_b128 v[144:147], v159 offset:640
    ds_read_b128 v[148:151], v159 offset:192
    ds_read_b128 v[152:155], v159 offset:704
    ds_read_b32 v104, v160 offset:0
    ds_read_b32 v105, v160 offset:16
    ds_read_b32 v106, v160 offset:32
    ds_read_b32 v107, v160 offset:48
    ds_read_b32 v108, v160 offset:64
    s_waitcnt vmcnt(0) lgkmcnt(0)
    v_pk_fma_f32 v[4:5], v[124:125], v[104:105], v[4:5] op_sel:[0,0,0] op_sel_hi:[1,0,1] neg_lo:[1,0,0] neg_hi:[1,0,0]
    v_pk_fma_f32 v[6:7], v[126:127], v[104:105], v[6:7] op_sel:[0,0,0] op_sel_hi:[1,0,1] neg_lo:[1,0,0] neg_hi:[1,0,0]
    v_pk_fma_f32 v[8:9], v[124:125], v[104:105], v[8:9] op_sel:[0,1,0] op_sel_hi:[1,1,1] neg_lo:[1,0,0] neg_hi:[1,0,0]
    v_pk_fma_f32 v[10:11], v[126:127], v[104:105], v[10:11] op_sel:[0,1,0] op_sel_hi:[1,1,1] neg_lo:[1,0,0] neg_hi:[1,0,0]
    v_pk_fma_f32 v[12:13], v[124:125], v[106:107], v[12:13] op_sel:[0,0,0] op_sel_hi:[1,0,1] neg_lo:[1,0,0] neg_hi:[1,0,0]
    v_pk_fma_f32 v[14:15], v[126:127], v[106:107], v[14:15] op_sel:[0,0,0] op_sel_hi:[1,0,1] neg_lo:[1,0,0] neg_hi:[1,0,0]
    v_pk_fma_f32 v[16:17], v[124:125], v[106:107], v[16:17] op_sel:[0,1,0] op_sel_hi:[1,1,1] neg_lo:[1,0,0] neg_hi:[1,0,0]
    v_pk_fma_f32 v[18:19], v[126:127], v[106:107], v[18:19] op_sel:[0,1,0] op_sel_hi:[1,1,1] neg_lo:[1,0,0] neg_hi:[1,0,0]
    v_pk_fma_f32 v[20:21], v[124:125], v[108:109], v[20:21] op_sel:[0,0,0] op_sel_hi:[1,0,1] neg_lo:[1,0,0] neg_hi:[1,0,0]
    v_pk_fma_f32 v[22:23], v[126:127], v[108:109], v[22:23] op_sel:[0,0,0] op_sel_hi:[1,0,1] neg_lo:[1,0,0] neg_hi:[1,0,0]
    v_pk_mul_f32 v[4:5], v[128:129], v[4:5] op_sel:[0,0] op_sel_hi:[1,1]
    v_pk_mul_f32 v[6:7], v[130:131], v[6:7] op_sel:[0,0] op_sel_hi:[1,1]
    v_pk_mul_f32 v[8:9], v[128:129], v[8:9] op_sel:[0,0] op_sel_hi:[1,1]
    v_pk_mul_f32 v[10:11], v[130:131], v[10:11] op_sel:[0,0] op_sel_hi:[1,1]
    v_pk_mul_f32 v[12:13], v[128:129], v[12:13] op_sel:[0,0] op_sel_hi:[1,1]
    v_pk_mul_f32 v[14:15], v[130:131], v[14:15] op_sel:[0,0] op_sel_hi:[1,1]
    v_pk_mul_f32 v[16:17], v[128:129], v[16:17] op_sel:[0,0] op_sel_hi:[1,1]
    v_pk_mul_f32 v[18:19], v[130:131], v[18:19] op_sel:[0,0] op_sel_hi:[1,1]
    v_pk_mul_f32 v[20:21], v[128:129], v[20:21] op_sel:[0,0] op_sel_hi:[1,1]
    v_pk_mul_f32 v[22:23], v[130:131], v[22:23] op_sel:[0,0] op_sel_hi:[1,1]
    v_pk_fma_f32 v[24:25], v[132:133], v[104:105], v[24:25] op_sel:[0,0,0] op_sel_hi:[1,0,1] neg_lo:[1,0,0] neg_hi:[1,0,0]
    v_pk_fma_f32 v[26:27], v[134:135], v[104:105], v[26:27] op_sel:[0,0,0] op_sel_hi:[1,0,1] neg_lo:[1,0,0] neg_hi:[1,0,0]
    v_pk_fma_f32 v[28:29], v[132:133], v[104:105], v[28:29] op_sel:[0,1,0] op_sel_hi:[1,1,1] neg_lo:[1,0,0] neg_hi:[1,0,0]
    v_pk_fma_f32 v[30:31], v[134:135], v[104:105], v[30:31] op_sel:[0,1,0] op_sel_hi:[1,1,1] neg_lo:[1,0,0] neg_hi:[1,0,0]
    v_pk_fma_f32 v[32:33], v[132:133], v[106:107], v[32:33] op_sel:[0,0,0] op_sel_hi:[1,0,1] neg_lo:[1,0,0] neg_hi:[1,0,0]
    v_pk_fma_f32 v[34:35], v[134:135], v[106:107], v[34:35] op_sel:[0,0,0] op_sel_hi:[1,0,1] neg_lo:[1,0,0] neg_hi:[1,0,0]
    v_pk_fma_f32 v[36:37], v[132:133], v[106:107], v[36:37] op_sel:[0,1,0] op_sel_hi:[1,1,1] neg_lo:[1,0,0] neg_hi:[1,0,0]
    v_pk_fma_f32 v[38:39], v[134:135], v[106:107], v[38:39] op_sel:[0,1,0] op_sel_hi:[1,1,1] neg_lo:[1,0,0] neg_hi:[1,0,0]
    v_pk_fma_f32 v[40:41], v[132:133], v[108:109], v[40:41] op_sel:[0,0,0] op_sel_hi:[1,0,1] neg_lo:[1,0,0] neg_hi:[1,0,0]
    v_pk_fma_f32 v[42:43], v[134:135], v[108:109], v[42:43] op_sel:[0,0,0] op_sel_hi:[1,0,1] neg_lo:[1,0,0] neg_hi:[1,0,0]
    v_pk_mul_f32 v[24:25], v[136:137], v[24:25] op_sel:[0,0] op_sel_hi:[1,1]
    v_pk_mul_f32 v[26:27], v[138:139], v[26:27] op_sel:[0,0] op_sel_hi:[1,1]
    v_pk_mul_f32 v[28:29], v[136:137], v[28:29] op_sel:[0,0] op_sel_hi:[1,1]
    v_pk_mul_f32 v[30:31], v[138:139], v[30:31] op_sel:[0,0] op_sel_hi:[1,1]
    v_pk_mul_f32 v[32:33], v[136:137], v[32:33] op_sel:[0,0] op_sel_hi:[1,1]
    v_pk_mul_f32 v[34:35], v[138:139], v[34:35] op_sel:[0,0] op_sel_hi:[1,1]
    v_pk_mul_f32 v[36:37], v[136:137], v[36:37] op_sel:[0,0] op_sel_hi:[1,1]
    v_pk_mul_f32 v[38:39], v[138:139], v[38:39] op_sel:[0,0] op_sel_hi:[1,1]
    v_pk_mul_f32 v[40:41], v[136:137], v[40:41] op_sel:[0,0] op_sel_hi:[1,1]
    v_pk_mul_f32 v[42:43], v[138:139], v[42:43] op_sel:[0,0] op_sel_hi:[1,1]
    v_cvt_pk_bf16_f32 v84, v4, v5
    v_cvt_pk_bf16_f32 v85, v6, v7
    v_cvt_pk_bf16_f32 v86, v24, v25
    v_cvt_pk_bf16_f32 v87, v26, v27
    buffer_store_dwordx4 v[84:87], v162, s[16:19], s28 offen offset:0 sc1
    v_cvt_pk_bf16_f32 v88, v8, v9
    v_cvt_pk_bf16_f32 v89, v10, v11
    v_cvt_pk_bf16_f32 v90, v28, v29
    v_cvt_pk_bf16_f32 v91, v30, v31
    buffer_store_dwordx4 v[88:91], v163, s[16:19], s28 offen offset:256 sc1
    v_cvt_pk_bf16_f32 v92, v12, v13
    v_cvt_pk_bf16_f32 v93, v14, v15
    v_cvt_pk_bf16_f32 v94, v32, v33
    v_cvt_pk_bf16_f32 v95, v34, v35
    buffer_store_dwordx4 v[92:95], v164, s[16:19], s28 offen offset:512 sc1
    v_cvt_pk_bf16_f32 v96, v16, v17
    v_cvt_pk_bf16_f32 v97, v18, v19
    v_cvt_pk_bf16_f32 v98, v36, v37
    v_cvt_pk_bf16_f32 v99, v38, v39
    buffer_store_dwordx4 v[96:99], v165, s[16:19], s28 offen offset:768 sc1
    v_cvt_pk_bf16_f32 v100, v20, v21
    v_cvt_pk_bf16_f32 v101, v22, v23
    v_cvt_pk_bf16_f32 v102, v40, v41
    v_cvt_pk_bf16_f32 v103, v42, v43
    buffer_store_dwordx4 v[100:103], v162, s[16:19], s28 offen offset:1024 sc1
    v_pk_fma_f32 v[44:45], v[140:141], v[104:105], v[44:45] op_sel:[0,0,0] op_sel_hi:[1,0,1] neg_lo:[1,0,0] neg_hi:[1,0,0]
    v_pk_fma_f32 v[46:47], v[142:143], v[104:105], v[46:47] op_sel:[0,0,0] op_sel_hi:[1,0,1] neg_lo:[1,0,0] neg_hi:[1,0,0]
    v_pk_fma_f32 v[48:49], v[140:141], v[104:105], v[48:49] op_sel:[0,1,0] op_sel_hi:[1,1,1] neg_lo:[1,0,0] neg_hi:[1,0,0]
    v_pk_fma_f32 v[50:51], v[142:143], v[104:105], v[50:51] op_sel:[0,1,0] op_sel_hi:[1,1,1] neg_lo:[1,0,0] neg_hi:[1,0,0]
    v_pk_fma_f32 v[52:53], v[140:141], v[106:107], v[52:53] op_sel:[0,0,0] op_sel_hi:[1,0,1] neg_lo:[1,0,0] neg_hi:[1,0,0]
    v_pk_fma_f32 v[54:55], v[142:143], v[106:107], v[54:55] op_sel:[0,0,0] op_sel_hi:[1,0,1] neg_lo:[1,0,0] neg_hi:[1,0,0]
    v_pk_fma_f32 v[56:57], v[140:141], v[106:107], v[56:57] op_sel:[0,1,0] op_sel_hi:[1,1,1] neg_lo:[1,0,0] neg_hi:[1,0,0]
    v_pk_fma_f32 v[58:59], v[142:143], v[106:107], v[58:59] op_sel:[0,1,0] op_sel_hi:[1,1,1] neg_lo:[1,0,0] neg_hi:[1,0,0]
    v_pk_fma_f32 v[60:61], v[140:141], v[108:109], v[60:61] op_sel:[0,0,0] op_sel_hi:[1,0,1] neg_lo:[1,0,0] neg_hi:[1,0,0]
    v_pk_fma_f32 v[62:63], v[142:143], v[108:109], v[62:63] op_sel:[0,0,0] op_sel_hi:[1,0,1] neg_lo:[1,0,0] neg_hi:[1,0,0]
    v_pk_mul_f32 v[44:45], v[144:145], v[44:45] op_sel:[0,0] op_sel_hi:[1,1]
    v_pk_mul_f32 v[46:47], v[146:147], v[46:47] op_sel:[0,0] op_sel_hi:[1,1]
    v_pk_mul_f32 v[48:49], v[144:145], v[48:49] op_sel:[0,0] op_sel_hi:[1,1]
    v_pk_mul_f32 v[50:51], v[146:147], v[50:51] op_sel:[0,0] op_sel_hi:[1,1]
    v_pk_mul_f32 v[52:53], v[144:145], v[52:53] op_sel:[0,0] op_sel_hi:[1,1]
    v_pk_mul_f32 v[54:55], v[146:147], v[54:55] op_sel:[0,0] op_sel_hi:[1,1]
    v_pk_mul_f32 v[56:57], v[144:145], v[56:57] op_sel:[0,0] op_sel_hi:[1,1]
    v_pk_mul_f32 v[58:59], v[146:147], v[58:59] op_sel:[0,0] op_sel_hi:[1,1]
    v_pk_mul_f32 v[60:61], v[144:145], v[60:61] op_sel:[0,0] op_sel_hi:[1,1]
    v_pk_mul_f32 v[62:63], v[146:147], v[62:63] op_sel:[0,0] op_sel_hi:[1,1]
    v_pk_fma_f32 v[64:65], v[148:149], v[104:105], v[64:65] op_sel:[0,0,0] op_sel_hi:[1,0,1] neg_lo:[1,0,0] neg_hi:[1,0,0]
    v_pk_fma_f32 v[66:67], v[150:151], v[104:105], v[66:67] op_sel:[0,0,0] op_sel_hi:[1,0,1] neg_lo:[1,0,0] neg_hi:[1,0,0]
    v_pk_fma_f32 v[68:69], v[148:149], v[104:105], v[68:69] op_sel:[0,1,0] op_sel_hi:[1,1,1] neg_lo:[1,0,0] neg_hi:[1,0,0]
    v_pk_fma_f32 v[70:71], v[150:151], v[104:105], v[70:71] op_sel:[0,1,0] op_sel_hi:[1,1,1] neg_lo:[1,0,0] neg_hi:[1,0,0]
    v_pk_fma_f32 v[72:73], v[148:149], v[106:107], v[72:73] op_sel:[0,0,0] op_sel_hi:[1,0,1] neg_lo:[1,0,0] neg_hi:[1,0,0]
    v_pk_fma_f32 v[74:75], v[150:151], v[106:107], v[74:75] op_sel:[0,0,0] op_sel_hi:[1,0,1] neg_lo:[1,0,0] neg_hi:[1,0,0]
    v_pk_fma_f32 v[76:77], v[148:149], v[106:107], v[76:77] op_sel:[0,1,0] op_sel_hi:[1,1,1] neg_lo:[1,0,0] neg_hi:[1,0,0]
    v_pk_fma_f32 v[78:79], v[150:151], v[106:107], v[78:79] op_sel:[0,1,0] op_sel_hi:[1,1,1] neg_lo:[1,0,0] neg_hi:[1,0,0]
    v_pk_fma_f32 v[80:81], v[148:149], v[108:109], v[80:81] op_sel:[0,0,0] op_sel_hi:[1,0,1] neg_lo:[1,0,0] neg_hi:[1,0,0]
    v_pk_fma_f32 v[82:83], v[150:151], v[108:109], v[82:83] op_sel:[0,0,0] op_sel_hi:[1,0,1] neg_lo:[1,0,0] neg_hi:[1,0,0]
    v_pk_mul_f32 v[64:65], v[152:153], v[64:65] op_sel:[0,0] op_sel_hi:[1,1]
    v_pk_mul_f32 v[66:67], v[154:155], v[66:67] op_sel:[0,0] op_sel_hi:[1,1]
    v_pk_mul_f32 v[68:69], v[152:153], v[68:69] op_sel:[0,0] op_sel_hi:[1,1]
    v_pk_mul_f32 v[70:71], v[154:155], v[70:71] op_sel:[0,0] op_sel_hi:[1,1]
    v_pk_mul_f32 v[72:73], v[152:153], v[72:73] op_sel:[0,0] op_sel_hi:[1,1]
    v_pk_mul_f32 v[74:75], v[154:155], v[74:75] op_sel:[0,0] op_sel_hi:[1,1]
    v_pk_mul_f32 v[76:77], v[152:153], v[76:77] op_sel:[0,0] op_sel_hi:[1,1]
    v_pk_mul_f32 v[78:79], v[154:155], v[78:79] op_sel:[0,0] op_sel_hi:[1,1]
    v_pk_mul_f32 v[80:81], v[152:153], v[80:81] op_sel:[0,0] op_sel_hi:[1,1]
    v_pk_mul_f32 v[82:83], v[154:155], v[82:83] op_sel:[0,0] op_sel_hi:[1,1]
    v_cvt_pk_bf16_f32 v84, v44, v45
    v_cvt_pk_bf16_f32 v85, v46, v47
    v_cvt_pk_bf16_f32 v86, v64, v65
    v_cvt_pk_bf16_f32 v87, v66, v67
    buffer_store_dwordx4 v[84:87], v162, s[16:19], s28 offen offset:2560 sc1
    v_cvt_pk_bf16_f32 v88, v48, v49
    v_cvt_pk_bf16_f32 v89, v50, v51
    v_cvt_pk_bf16_f32 v90, v68, v69
    v_cvt_pk_bf16_f32 v91, v70, v71
    buffer_store_dwordx4 v[88:91], v163, s[16:19], s28 offen offset:2816 sc1
    v_cvt_pk_bf16_f32 v92, v52, v53
    v_cvt_pk_bf16_f32 v93, v54, v55
    v_cvt_pk_bf16_f32 v94, v72, v73
    v_cvt_pk_bf16_f32 v95, v74, v75
    buffer_store_dwordx4 v[92:95], v164, s[16:19], s28 offen offset:3072 sc1
    v_cvt_pk_bf16_f32 v96, v56, v57
    v_cvt_pk_bf16_f32 v97, v58, v59
    v_cvt_pk_bf16_f32 v98, v76, v77
    v_cvt_pk_bf16_f32 v99, v78, v79
    buffer_store_dwordx4 v[96:99], v165, s[16:19], s28 offen offset:3328 sc1
    v_cvt_pk_bf16_f32 v100, v60, v61
    v_cvt_pk_bf16_f32 v101, v62, v63
    v_cvt_pk_bf16_f32 v102, v80, v81
    v_cvt_pk_bf16_f32 v103, v82, v83
    buffer_store_dwordx4 v[100:103], v162, s[16:19], s28 offen offset:3584 sc1
    s_endpgm
L1_spare:
    s_load_dwordx2 s[36:37], s[0:1], 32
    s_load_dwordx2 s[78:79], s[0:1], 16
    s_and_b32 s21, s2, 7
    s_lshr_b32 s22, s2, 3
    v_mov_b32 v3, 66560
    s_cmp_ge_u32 s20, 4
    s_cbranch_scc1 LS_cw
    s_lshr_b32 s38, s21, 1
    s_lshl_b32 s38, s38, 9
    s_and_b32 s39, s21, 1
    s_lshl_b32 s39, s39, 3
    s_add_u32 s39, s39, s22
    s_lshl_b32 s39, s39, 5
    s_add_u32 s38, s38, s39
    s_lshl_b32 s39, s20, 3
    s_add_u32 s38, s38, s39
    v_lshrrev_b32 v118, 4, v0
    v_add_u32 v118, s38, v118
    v_and_b32 v116, 15, v0
    v_lshlrev_b32 v115, 4, v116
    v_mul_u32_u24 v114, 1280, v118
    v_add_u32 v114, v114, v115
    v_mov_b32 v64, 0
    v_mov_b32 v65, 0
    v_mov_b32 v66, 0
    v_mov_b32 v67, 0
    ds_write_b128 v3, v[64:67]
    s_movk_i32 s39, 5120
    s_waitcnt lgkmcnt(0)
    s_mov_b32 s8, s4
    s_mov_b32 s9, s5
    s_mov_b32 s10, 0x280000
    s_mov_b32 s11, 0x20000
    buffer_load_dwordx4 v[4:7], v114, s[8:11], 0 offen offset:0
    buffer_load_dwordx4 v[8:11], v114, s[8:11], 0 offen offset:256
    buffer_load_dwordx4 v[12:15], v114, s[8:11], 0 offen offset:512
    buffer_load_dwordx4 v[16:19], v114, s[8:11], 0 offen offset:768
    buffer_load_dwordx4 v[20:23], v114, s[8:11], 0 offen offset:1024
    buffer_load_dwordx4 v[24:27], v114, s[8:11], s39 offen offset:0
    buffer_load_dwordx4 v[28:31], v114, s[8:11], s39 offen offset:256
    buffer_load_dwordx4 v[32:35], v114, s[8:11], s39 offen offset:512
    buffer_load_dwordx4 v[36:39], v114, s[8:11], s39 offen offset:768
    buffer_load_dwordx4 v[40:43], v114, s[8:11], s39 offen offset:1024
    s_mov_b32 s16, s42
    s_mov_b32 s17, s43
    s_mov_b32 s18, 0x1100000
    s_mov_b32 s19, 0x20000
    s_mov_b32 s44, s40
    s_mov_b32 s45, s41
    s_mov_b32 s46, 0x100
    s_mov_b32 s47, 0x20000
    s_barrier
    s_mov_b32 s38, 0x3f803f80
    v_mov_b32 v104, 0
    v_mov_b32 v105, 0
    v_mov_b32 v106, 0
    v_mov_b32 v107, 0
    v_mov_b32 v112, 0
    v_mov_b32 v113, 0
    v_lshl_add_u32 v118, v116, 2, v118
    v_cmp_eq_u32 s[32:33], 1, v116
    v_cmp_gt_u32 s[34:35], 2, v116
    v_lshlrev_b32 v119, 2, v118
    s_waitcnt vmcnt(0)
    v_dot2c_f32_bf16 v104, s38, v4
    v_dot2c_f32_bf16 v106, v4, v4
    v_dot2c_f32_bf16 v105, s38, v24
    v_dot2c_f32_bf16 v107, v24, v24
    v_dot2c_f32_bf16 v104, s38, v5
    v_dot2c_f32_bf16 v106, v5, v5
    v_dot2c_f32_bf16 v105, s38, v25
    v_dot2c_f32_bf16 v107, v25, v25
    v_dot2c_f32_bf16 v104, s38, v6
    v_dot2c_f32_bf16 v106, v6, v6
    v_dot2c_f32_bf16 v105, s38, v26
    v_dot2c_f32_bf16 v107, v26, v26
    v_dot2c_f32_bf16 v104, s38, v7
    v_dot2c_f32_bf16 v106, v7, v7
    v_dot2c_f32_bf16 v105, s38, v27
    v_dot2c_f32_bf16 v107, v27, v27
    v_dot2c_f32_bf16 v104, s38, v8
    v_dot2c_f32_bf16 v106, v8, v8
    v_dot2c_f32_bf16 v105, s38, v28
    v_dot2c_f32_bf16 v107, v28, v28
    v_dot2c_f32_bf16 v104, s38, v9
    v_dot2c_f32_bf16 v106, v9, v9
    v_dot2c_f32_bf16 v105, s38, v29
    v_dot2c_f32_bf16 v107, v29, v29
    v_dot2c_f32_bf16 v104, s38, v10
    v_dot2c_f32_bf16 v106, v10, v10
    v_dot2c_f32_bf16 v105, s38, v30
    v_dot2c_f32_bf16 v107, v30, v30
    v_dot2c_f32_bf16 v104, s38, v11
    v_dot2c_f32_bf16 v106, v11, v11
    v_dot2c_f32_bf16 v105, s38, v31
    v_dot2c_f32_bf16 v107, v31, v31
    v_dot2c_f32_bf16 v104, s38, v12
    v_dot2c_f32_bf16 v106, v12, v12
    v_dot2c_f32_bf16 v105, s38, v32
    v_dot2c_f32_bf16 v107, v32, v32
    v_dot2c_f32_bf16 v104, s38, v13
    v_dot2c_f32_bf16 v106, v13, v13
    v_dot2c_f32_bf16 v105, s38, v33
    v_dot2c_f32_bf16 v107, v33, v33
    v_dot2c_f32_bf16 v104, s38, v14
    v_dot2c_f32_bf16 v106, v14, v14
    v_dot2c_f32_bf16 v105, s38, v34
    v_dot2c_f32_bf16 v107, v34, v34
    v_dot2c_f32_bf16 v104, s38, v15
    v_dot2c_f32_bf16 v106, v15, v15
    v_dot2c_f32_bf16 v105, s38, v35
    v_dot2c_f32_bf16 v107, v35, v35
    v_dot2c_f32_bf16 v104, s38, v16
    v_dot2c_f32_bf16 v106, v16, v16
    v_dot2c_f32_bf16 v105, s38, v36
    v_dot2c_f32_bf16 v107, v36, v36
    v_dot2c_f32_bf16 v104, s38, v17
    v_dot2c_f32_bf16 v106, v17, v17
    v_dot2c_f32_bf16 v105, s38, v37
    v_dot2c_f32_bf16 v107, v37, v37
    v_dot2c_f32_bf16 v104, s38, v18
    v_dot2c_f32_bf16 v106, v18, v18
    v_dot2c_f32_bf16 v105, s38, v38
    v_dot2c_f32_bf16 v107, v38, v38
    v_dot2c_f32_bf16 v104, s38, v19
    v_dot2c_f32_bf16 v106, v19, v19
    v_dot2c_f32_bf16 v105, s38, v39
    v_dot2c_f32_bf16 v107, v39, v39
    v_dot2c_f32_bf16 v104, s38, v20
    v_dot2c_f32_bf16 v106, v20, v20
    v_dot2c_f32_bf16 v105, s38, v40
    v_dot2c_f32_bf16 v107, v40, v40
    v_dot2c_f32_bf16 v104, s38, v21
    v_dot2c_f32_bf16 v106, v21, v21
    v_dot2c_f32_bf16 v105, s38, v41
    v_dot2c_f32_bf16 v107, v41, v41
    v_dot2c_f32_bf16 v104, s38, v22
    v_dot2c_f32_bf16 v106, v22, v22
    v_dot2c_f32_bf16 v105, s38, v42
    v_dot2c_f32_bf16 v107, v42, v42
    v_dot2c_f32_bf16 v104, s38, v23
    v_dot2c_f32_bf16 v106, v23, v23
    v_dot2c_f32_bf16 v105, s38, v43
    v_dot2c_f32_bf16 v107, v43, v43
    s_nop 2
    v_add_f32_dpp v104, v104, v104 quad_perm:[1,0,3,2] row_mask:0xf bank_mask:0xf
    v_add_f32_dpp v105, v105, v105 quad_perm:[1,0,3,2] row_mask:0xf bank_mask:0xf
    v_add_f32_dpp v106, v106, v106 quad_perm:[1,0,3,2] row_mask:0xf bank_mask:0xf
    v_add_f32_dpp v107, v107, v107 quad_perm:[1,0,3,2] row_mask:0xf bank_mask:0xf
    v_add_f32_dpp v104, v104, v104 quad_perm:[2,3,0,1] row_mask:0xf bank_mask:0xf
    v_add_f32_dpp v105, v105, v105 quad_perm:[2,3,0,1] row_mask:0xf bank_mask:0xf
    v_add_f32_dpp v106, v106, v106 quad_perm:[2,3,0,1] row_mask:0xf bank_mask:0xf
    v_add_f32_dpp v107, v107, v107 quad_perm:[2,3,0,1] row_mask:0xf bank_mask:0xf
    v_add_f32_dpp v104, v104, v104 row_half_mirror row_mask:0xf bank_mask:0xf
    v_add_f32_dpp v105, v105, v105 row_half_mirror row_mask:0xf bank_mask:0xf
    v_add_f32_dpp v106, v106, v106 row_half_mirror row_mask:0xf bank_mask:0xf
    v_add_f32_dpp v107, v107, v107 row_half_mirror row_mask:0xf bank_mask:0xf
    v_add_f32_dpp v104, v104, v104 row_mirror row_mask:0xf bank_mask:0xf
    v_add_f32_dpp v105, v105, v105 row_mirror row_mask:0xf bank_mask:0xf
    v_add_f32_dpp v106, v106, v106 row_mirror row_mask:0xf bank_mask:0xf
    v_add_f32_dpp v107, v107, v107 row_mirror row_mask:0xf bank_mask:0xf
    v_mul_f32 v108, 0x3acccccd, v104
    v_mul_f32 v116, 0x3acccccd, v106
    v_fma_f32 v116, -v108, v108, v116
    v_max_f32 v116, 0, v116
    v_cvt_pk_bf16_f32 v116, v116, v116
    v_and_b32 v116, 0xffff0000, v116
    v_add_f32 v116, 0x3727c5ac, v116
    v_cvt_pk_bf16_f32 v116, v116, v116
    v_and_b32 v116, 0xffff0000, v116
    v_sqrt_f32 v116, v116
    v_cvt_pk_bf16_f32 v108, v108, v108
    v_and_b32 v108, 0xffff0000, v108
    v_cvt_pk_bf16_f32 v116, v116, v116
    v_and_b32 v116, 0xffff0000, v116
    v_rcp_f32 v109, v116
    v_mul_f32 v110, 0x3acccccd, v105
    v_mul_f32 v116, 0x3acccccd, v107
    v_fma_f32 v116, -v110, v110, v116
    v_max_f32 v116, 0, v116
    v_cvt_pk_bf16_f32 v116, v116, v116
    v_and_b32 v116, 0xffff0000, v116
    v_add_f32 v116, 0x3727c5ac, v116
    v_cvt_pk_bf16_f32 v116, v116, v116
    v_and_b32 v116, 0xffff0000, v116
    v_sqrt_f32 v116, v116
    v_cvt_pk_bf16_f32 v110, v110, v110
    v_and_b32 v110, 0xffff0000, v110
    v_cvt_pk_bf16_f32 v116, v116, v116
    v_and_b32 v116, 0xffff0000, v116
    v_rcp_f32 v111, v116
    s_mov_b32 s38, 0xb00000
    s_mov_b32 s39, 0xb02000
    v_cndmask_b32 v116, v108, v110, s[32:33]
    v_cndmask_b32 v117, v109, v111, s[32:33]
    s_mov_b64 exec, s[34:35]
    buffer_store_dword v116, v119, s[16:19], s38 offen sc1
    buffer_store_dword v117, v119, s[16:19], s39 offen sc1
    s_mov_b64 exec, -1
    s_mov_b32 s12, s36
    s_mov_b32 s13, s37
    s_mov_b32 s14, 0x500
    s_mov_b32 s15, 0x20000
    buffer_load_dwordx4 v[44:47], v115, s[12:15], 0 offen offset:0
    buffer_load_dwordx4 v[48:51], v115, s[12:15], 0 offen offset:256
    buffer_load_dwordx4 v[52:55], v115, s[12:15], 0 offen offset:512
    buffer_load_dwordx4 v[56:59], v115, s[12:15], 0 offen offset:768
    buffer_load_dwordx4 v[60:63], v115, s[12:15], 0 offen offset:1024
    v_lshlrev_b32 v64, 16, v4
    v_and_b32 v65, 0xffff0000, v4
    v_lshlrev_b32 v66, 16, v5
    v_and_b32 v67, 0xffff0000, v5
    v_lshlrev_b32 v68, 16, v6
    v_and_b32 v69, 0xffff0000, v6
    v_lshlrev_b32 v70, 16, v7
    v_and_b32 v71, 0xffff0000, v7
    v_lshlrev_b32 v72, 16, v8
    v_and_b32 v73, 0xffff0000, v8
    v_lshlrev_b32 v74, 16, v9
    v_and_b32 v75, 0xffff0000, v9
    v_lshlrev_b32 v76, 16, v10
    v_and_b32 v77, 0xffff0000, v10
    v_lshlrev_b32 v78, 16, v11
    v_and_b32 v79, 0xffff0000, v11
    v_lshlrev_b32 v80, 16, v12
    v_and_b32 v81, 0xffff0000, v12
    v_lshlrev_b32 v82, 16, v13
    v_and_b32 v83, 0xffff0000, v13
    v_lshlrev_b32 v84, 16, v14
    v_and_b32 v85, 0xffff0000, v14
    v_lshlrev_b32 v86, 16, v15
    v_and_b32 v87, 0xffff0000, v15
    v_lshlrev_b32 v88, 16, v16
    v_and_b32 v89, 0xffff0000, v16
    v_lshlrev_b32 v90, 16, v17
    v_and_b32 v91, 0xffff0000, v17
    v_lshlrev_b32 v92, 16, v18
    v_and_b32 v93, 0xffff0000, v18
    v_lshlrev_b32 v94, 16, v19
    v_and_b32 v95, 0xffff0000, v19
    v_lshlrev_b32 v96, 16, v20
    v_and_b32 v97, 0xffff0000, v20
    v_lshlrev_b32 v98, 16, v21
    v_and_b32 v99, 0xffff0000, v21
    v_lshlrev_b32 v100, 16, v22
    v_and_b32 v101, 0xffff0000, v22
    v_lshlrev_b32 v102, 16, v23
    v_and_b32 v103, 0xffff0000, v23
    v_pk_add_f32 v[64:65], v[64:65], v[108:109] op_sel:[0,0] op_sel_hi:[1,0] neg_lo:[0,1] neg_hi:[0,1]
    v_pk_add_f32 v[66:67], v[66:67], v[108:109] op_sel:[0,0] op_sel_hi:[1,0] neg_lo:[0,1] neg_hi:[0,1]
    v_pk_add_f32 v[68:69], v[68:69], v[108:109] op_sel:[0,0] op_sel_hi:[1,0] neg_lo:[0,1] neg_hi:[0,1]
    v_pk_add_f32 v[70:71], v[70:71], v[108:109] op_sel:[0,0] op_sel_hi:[1,0] neg_lo:[0,1] neg_hi:[0,1]
    v_pk_add_f32 v[72:73], v[72:73], v[108:109] op_sel:[0,0] op_sel_hi:[1,0] neg_lo:[0,1] neg_hi:[0,1]
    v_pk_add_f32 v[74:75], v[74:75], v[108:109] op_sel:[0,0] op_sel_hi:[1,0] neg_lo:[0,1] neg_hi:[0,1]
    v_pk_add_f32 v[76:77], v[76:77], v[108:109] op_sel:[0,0] op_sel_hi:[1,0] neg_lo:[0,1] neg_hi:[0,1]
    v_pk_add_f32 v[78:79], v[78:79], v[108:109] op_sel:[0,0] op_sel_hi:[1,0] neg_lo:[0,1] neg_hi:[0,1]
    v_pk_add_f32 v[80:81], v[80:81], v[108:109] op_sel:[0,0] op_sel_hi:[1,0] neg_lo:[0,1] neg_hi:[0,1]
    v_pk_add_f32 v[82:83], v[82:83], v[108:109] op_sel:[0,0] op_sel_hi:[1,0] neg_lo:[0,1] neg_hi:[0,1]
    v_pk_add_f32 v[84:85], v[84:85], v[108:109] op_sel:[0,0] op_sel_hi:[1,0] neg_lo:[0,1] neg_hi:[0,1]
    v_pk_add_f32 v[86:87], v[86:87], v[108:109] op_sel:[0,0] op_sel_hi:[1,0] neg_lo:[0,1] neg_hi:[0,1]
    v_pk_add_f32 v[88:89], v[88:89], v[108:109] op_sel:[0,0] op_sel_hi:[1,0] neg_lo:[0,1] neg_hi:[0,1]
    v_pk_add_f32 v[90:91], v[90:91], v[108:109] op_sel:[0,0] op_sel_hi:[1,0] neg_lo:[0,1] neg_hi:[0,1]
    v_pk_add_f32 v[92:93], v[92:93], v[108:109] op_sel:[0,0] op_sel_hi:[1,0] neg_lo:[0,1] neg_hi:[0,1]
    v_pk_add_f32 v[94:95], v[94:95], v[108:109] op_sel:[0,0] op_sel_hi:[1,0] neg_lo:[0,1] neg_hi:[0,1]
    v_pk_add_f32 v[96:97], v[96:97], v[108:109] op_sel:[0,0] op_sel_hi:[1,0] neg_lo:[0,1] neg_hi:[0,1]
    v_pk_add_f32 v[98:99], v[98:99], v[108:109] op_sel:[0,0] op_sel_hi:[1,0] neg_lo:[0,1] neg_hi:[0,1]
    v_pk_add_f32 v[100:101], v[100:101], v[108:109] op_sel:[0,0] op_sel_hi:[1,0] neg_lo:[0,1] neg_hi:[0,1]
    v_pk_add_f32 v[102:103], v[102:103], v[108:109] op_sel:[0,0] op_sel_hi:[1,0] neg_lo:[0,1] neg_hi:[0,1]
    v_cvt_pk_bf16_f32 v4, v64, v65
    v_cvt_pk_bf16_f32 v5, v66, v67
    v_cvt_pk_bf16_f32 v6, v68, v69
    v_cvt_pk_bf16_f32 v7, v70, v71
    v_cvt_pk_bf16_f32 v8, v72, v73
    v_cvt_pk_bf16_f32 v9, v74, v75
    v_cvt_pk_bf16_f32 v10, v76, v77
    v_cvt_pk_bf16_f32 v11, v78, v79
    v_cvt_pk_bf16_f32 v12, v80, v81
    v_cvt_pk_bf16_f32 v13, v82, v83
    v_cvt_pk_bf16_f32 v14, v84, v85
    v_cvt_pk_bf16_f32 v15, v86, v87
    v_cvt_pk_bf16_f32 v16, v88, v89
    v_cvt_pk_bf16_f32 v17, v90, v91
    v_cvt_pk_bf16_f32 v18, v92, v93
    v_cvt_pk_bf16_f32 v19, v94, v95
    v_cvt_pk_bf16_f32 v20, v96, v97
    v_cvt_pk_bf16_f32 v21, v98, v99
    v_cvt_pk_bf16_f32 v22, v100, v101
    v_cvt_pk_bf16_f32 v23, v102, v103
    s_waitcnt vmcnt(5)
    v_mov_b32 v117, 1
    s_mov_b64 exec, 1
    ds_add_rtn_u32 v116, v3, v117 offset:4
    s_waitcnt lgkmcnt(0)
    v_readfirstlane_b32 s38, v116
    v_mov_b32 v116, 0
    s_cmp_lg_u32 s38, 4
    s_cbranch_scc1 LS_ns1379
    buffer_atomic_add v117, v116, s[44:47], 0 offen sc0 sc1
    s_waitcnt vmcnt(0)
    v_readfirstlane_b32 s38, v117
    v_mov_b32 v117, 64
    s_cmp_lg_u32 s38, 63
    s_cbranch_scc1 LS_ns1379
    buffer_store_dword v117, v116, s[44:47], 0 offen offset:128 sc1
LS_ns1379:
    s_mov_b64 exec, -1
    v_lshlrev_b32 v64, 16, v4
    v_and_b32 v65, 0xffff0000, v4
    v_lshlrev_b32 v66, 16, v5
    v_and_b32 v67, 0xffff0000, v5
    v_lshlrev_b32 v68, 16, v6
    v_and_b32 v69, 0xffff0000, v6
    v_lshlrev_b32 v70, 16, v7
    v_and_b32 v71, 0xffff0000, v7
    v_lshlrev_b32 v72, 16, v8
    v_and_b32 v73, 0xffff0000, v8
    v_lshlrev_b32 v74, 16, v9
    v_and_b32 v75, 0xffff0000, v9
    v_lshlrev_b32 v76, 16, v10
    v_and_b32 v77, 0xffff0000, v10
    v_lshlrev_b32 v78, 16, v11
    v_and_b32 v79, 0xffff0000, v11
    v_lshlrev_b32 v80, 16, v12
    v_and_b32 v81, 0xffff0000, v12
    v_lshlrev_b32 v82, 16, v13
    v_and_b32 v83, 0xffff0000, v13
    v_lshlrev_b32 v84, 16, v14
    v_and_b32 v85, 0xffff0000, v14
    v_lshlrev_b32 v86, 16, v15
    v_and_b32 v87, 0xffff0000, v15
    v_lshlrev_b32 v88, 16, v16
    v_and_b32 v89, 0xffff0000, v16
    v_lshlrev_b32 v90, 16, v17
    v_and_b32 v91, 0xffff0000, v17
    v_lshlrev_b32 v92, 16, v18
    v_and_b32 v93, 0xffff0000, v18
    v_lshlrev_b32 v94, 16, v19
    v_and_b32 v95, 0xffff0000, v19
    v_lshlrev_b32 v96, 16, v20
    v_and_b32 v97, 0xffff0000, v20
    v_lshlrev_b32 v98, 16, v21
    v_and_b32 v99, 0xffff0000, v21
    v_lshlrev_b32 v100, 16, v22
    v_and_b32 v101, 0xffff0000, v22
    v_lshlrev_b32 v102, 16, v23
    v_and_b32 v103, 0xffff0000, v23
    v_pk_mul_f32 v[64:65], v[64:65], v[108:109] op_sel:[0,1] op_sel_hi:[1,1]
    v_pk_mul_f32 v[66:67], v[66:67], v[108:109] op_sel:[0,1] op_sel_hi:[1,1]
    v_pk_mul_f32 v[68:69], v[68:69], v[108:109] op_sel:[0,1] op_sel_hi:[1,1]
    v_pk_mul_f32 v[70:71], v[70:71], v[108:109] op_sel:[0,1] op_sel_hi:[1,1]
    v_pk_mul_f32 v[72:73], v[72:73], v[108:109] op_sel:[0,1] op_sel_hi:[1,1]
    v_pk_mul_f32 v[74:75], v[74:75], v[108:109] op_sel:[0,1] op_sel_hi:[1,1]
    v_pk_mul_f32 v[76:77], v[76:77], v[108:109] op_sel:[0,1] op_sel_hi:[1,1]
    v_pk_mul_f32 v[78:79], v[78:79], v[108:109] op_sel:[0,1] op_sel_hi:[1,1]
    v_pk_mul_f32 v[80:81], v[80:81], v[108:109] op_sel:[0,1] op_sel_hi:[1,1]
    v_pk_mul_f32 v[82:83], v[82:83], v[108:109] op_sel:[0,1] op_sel_hi:[1,1]
    v_pk_mul_f32 v[84:85], v[84:85], v[108:109] op_sel:[0,1] op_sel_hi:[1,1]
    v_pk_mul_f32 v[86:87], v[86:87], v[108:109] op_sel:[0,1] op_sel_hi:[1,1]
    v_pk_mul_f32 v[88:89], v[88:89], v[108:109] op_sel:[0,1] op_sel_hi:[1,1]
    v_pk_mul_f32 v[90:91], v[90:91], v[108:109] op_sel:[0,1] op_sel_hi:[1,1]
    v_pk_mul_f32 v[92:93], v[92:93], v[108:109] op_sel:[0,1] op_sel_hi:[1,1]
    v_pk_mul_f32 v[94:95], v[94:95], v[108:109] op_sel:[0,1] op_sel_hi:[1,1]
    v_pk_mul_f32 v[96:97], v[96:97], v[108:109] op_sel:[0,1] op_sel_hi:[1,1]
    v_pk_mul_f32 v[98:99], v[98:99], v[108:109] op_sel:[0,1] op_sel_hi:[1,1]
    v_pk_mul_f32 v[100:101], v[100:101], v[108:109] op_sel:[0,1] op_sel_hi:[1,1]
    v_pk_mul_f32 v[102:103], v[102:103], v[108:109] op_sel:[0,1] op_sel_hi:[1,1]
    v_cvt_pk_bf16_f32 v4, v64, v65
    v_cvt_pk_bf16_f32 v5, v66, v67
    v_cvt_pk_bf16_f32 v6, v68, v69
    v_cvt_pk_bf16_f32 v7, v70, v71
    v_cvt_pk_bf16_f32 v8, v72, v73
    v_cvt_pk_bf16_f32 v9, v74, v75
    v_cvt_pk_bf16_f32 v10, v76, v77
    v_cvt_pk_bf16_f32 v11, v78, v79
    v_cvt_pk_bf16_f32 v12, v80, v81
    v_cvt_pk_bf16_f32 v13, v82, v83
    v_cvt_pk_bf16_f32 v14, v84, v85
    v_cvt_pk_bf16_f32 v15, v86, v87
    v_cvt_pk_bf16_f32 v16, v88, v89
    v_cvt_pk_bf16_f32 v17, v90, v91
    v_cvt_pk_bf16_f32 v18, v92, v93
    v_cvt_pk_bf16_f32 v19, v94, v95
    v_cvt_pk_bf16_f32 v20, v96, v97
    v_cvt_pk_bf16_f32 v21, v98, v99
    v_cvt_pk_bf16_f32 v22, v100, v101
    v_cvt_pk_bf16_f32 v23, v102, v103
    s_waitcnt vmcnt(0)
    v_dot2c_f32_bf16 v112, v4, v44
    v_dot2c_f32_bf16 v112, v5, v45
    v_dot2c_f32_bf16 v112, v6, v46
    v_dot2c_f32_bf16 v112, v7, v47
    v_dot2c_f32_bf16 v112, v8, v48
    v_dot2c_f32_bf16 v112, v9, v49
    v_dot2c_f32_bf16 v112, v10, v50
    v_dot2c_f32_bf16 v112, v11, v51
    v_dot2c_f32_bf16 v112, v12, v52
    v_dot2c_f32_bf16 v112, v13, v53
    v_dot2c_f32_bf16 v112, v14, v54
    v_dot2c_f32_bf16 v112, v15, v55
    v_dot2c_f32_bf16 v112, v16, v56
    v_dot2c_f32_bf16 v112, v17, v57
    v_dot2c_f32_bf16 v112, v18, v58
    v_dot2c_f32_bf16 v112, v19, v59
    v_dot2c_f32_bf16 v112, v20, v60
    v_dot2c_f32_bf16 v112, v21, v61
    v_dot2c_f32_bf16 v112, v22, v62
    v_dot2c_f32_bf16 v112, v23, v63
    v_lshlrev_b32 v64, 16, v24
    v_and_b32 v65, 0xffff0000, v24
    v_lshlrev_b32 v66, 16, v25
    v_and_b32 v67, 0xffff0000, v25
    v_lshlrev_b32 v68, 16, v26
    v_and_b32 v69, 0xffff0000, v26
    v_lshlrev_b32 v70, 16, v27
    v_and_b32 v71, 0xffff0000, v27
    v_lshlrev_b32 v72, 16, v28
    v_and_b32 v73, 0xffff0000, v28
    v_lshlrev_b32 v74, 16, v29
    v_and_b32 v75, 0xffff0000, v29
    v_lshlrev_b32 v76, 16, v30
    v_and_b32 v77, 0xffff0000, v30
    v_lshlrev_b32 v78, 16, v31
    v_and_b32 v79, 0xffff0000, v31
    v_lshlrev_b32 v80, 16, v32
    v_and_b32 v81, 0xffff0000, v32
    v_lshlrev_b32 v82, 16, v33
    v_and_b32 v83, 0xffff0000, v33
    v_lshlrev_b32 v84, 16, v34
    v_and_b32 v85, 0xffff0000, v34
    v_lshlrev_b32 v86, 16, v35
    v_and_b32 v87, 0xffff0000, v35
    v_lshlrev_b32 v88, 16, v36
    v_and_b32 v89, 0xffff0000, v36
    v_lshlrev_b32 v90, 16, v37
    v_and_b32 v91, 0xffff0000, v37
    v_lshlrev_b32 v92, 16, v38
    v_and_b32 v93, 0xffff0000, v38
    v_lshlrev_b32 v94, 16, v39
    v_and_b32 v95, 0xffff0000, v39
    v_lshlrev_b32 v96, 16, v40
    v_and_b32 v97, 0xffff0000, v40
    v_lshlrev_b32 v98, 16, v41
    v_and_b32 v99, 0xffff0000, v41
    v_lshlrev_b32 v100, 16, v42
    v_and_b32 v101, 0xffff0000, v42
    v_lshlrev_b32 v102, 16, v43
    v_and_b32 v103, 0xffff0000, v43
    v_pk_add_f32 v[64:65], v[64:65], v[110:111] op_sel:[0,0] op_sel_hi:[1,0] neg_lo:[0,1] neg_hi:[0,1]
    v_pk_add_f32 v[66:67], v[66:67], v[110:111] op_sel:[0,0] op_sel_hi:[1,0] neg_lo:[0,1] neg_hi:[0,1]
    v_pk_add_f32 v[68:69], v[68:69], v[110:111] op_sel:[0,0] op_sel_hi:[1,0] neg_lo:[0,1] neg_hi:[0,1]
    v_pk_add_f32 v[70:71], v[70:71], v[110:111] op_sel:[0,0] op_sel_hi:[1,0] neg_lo:[0,1] neg_hi:[0,1]
    v_pk_add_f32 v[72:73], v[72:73], v[110:111] op_sel:[0,0] op_sel_hi:[1,0] neg_lo:[0,1] neg_hi:[0,1]
    v_pk_add_f32 v[74:75], v[74:75], v[110:111] op_sel:[0,0] op_sel_hi:[1,0] neg_lo:[0,1] neg_hi:[0,1]
    v_pk_add_f32 v[76:77], v[76:77], v[110:111] op_sel:[0,0] op_sel_hi:[1,0] neg_lo:[0,1] neg_hi:[0,1]
    v_pk_add_f32 v[78:79], v[78:79], v[110:111] op_sel:[0,0] op_sel_hi:[1,0] neg_lo:[0,1] neg_hi:[0,1]
    v_pk_add_f32 v[80:81], v[80:81], v[110:111] op_sel:[0,0] op_sel_hi:[1,0] neg_lo:[0,1] neg_hi:[0,1]
    v_pk_add_f32 v[82:83], v[82:83], v[110:111] op_sel:[0,0] op_sel_hi:[1,0] neg_lo:[0,1] neg_hi:[0,1]
    v_pk_add_f32 v[84:85], v[84:85], v[110:111] op_sel:[0,0] op_sel_hi:[1,0] neg_lo:[0,1] neg_hi:[0,1]
    v_pk_add_f32 v[86:87], v[86:87], v[110:111] op_sel:[0,0] op_sel_hi:[1,0] neg_lo:[0,1] neg_hi:[0,1]
    v_pk_add_f32 v[88:89], v[88:89], v[110:111] op_sel:[0,0] op_sel_hi:[1,0] neg_lo:[0,1] neg_hi:[0,1]
    v_pk_add_f32 v[90:91], v[90:91], v[110:111] op_sel:[0,0] op_sel_hi:[1,0] neg_lo:[0,1] neg_hi:[0,1]
    v_pk_add_f32 v[92:93], v[92:93], v[110:111] op_sel:[0,0] op_sel_hi:[1,0] neg_lo:[0,1] neg_hi:[0,1]
    v_pk_add_f32 v[94:95], v[94:95], v[110:111] op_sel:[0,0] op_sel_hi:[1,0] neg_lo:[0,1] neg_hi:[0,1]
    v_pk_add_f32 v[96:97], v[96:97], v[110:111] op_sel:[0,0] op_sel_hi:[1,0] neg_lo:[0,1] neg_hi:[0,1]
    v_pk_add_f32 v[98:99], v[98:99], v[110:111] op_sel:[0,0] op_sel_hi:[1,0] neg_lo:[0,1] neg_hi:[0,1]
    v_pk_add_f32 v[100:101], v[100:101], v[110:111] op_sel:[0,0] op_sel_hi:[1,0] neg_lo:[0,1] neg_hi:[0,1]
    v_pk_add_f32 v[102:103], v[102:103], v[110:111] op_sel:[0,0] op_sel_hi:[1,0] neg_lo:[0,1] neg_hi:[0,1]
    v_cvt_pk_bf16_f32 v24, v64, v65
    v_cvt_pk_bf16_f32 v25, v66, v67
    v_cvt_pk_bf16_f32 v26, v68, v69
    v_cvt_pk_bf16_f32 v27, v70, v71
    v_cvt_pk_bf16_f32 v28, v72, v73
    v_cvt_pk_bf16_f32 v29, v74, v75
    v_cvt_pk_bf16_f32 v30, v76, v77
    v_cvt_pk_bf16_f32 v31, v78, v79
    v_cvt_pk_bf16_f32 v32, v80, v81
    v_cvt_pk_bf16_f32 v33, v82, v83
    v_cvt_pk_bf16_f32 v34, v84, v85
    v_cvt_pk_bf16_f32 v35, v86, v87
    v_cvt_pk_bf16_f32 v36, v88, v89
    v_cvt_pk_bf16_f32 v37, v90, v91
    v_cvt_pk_bf16_f32 v38, v92, v93
    v_cvt_pk_bf16_f32 v39, v94, v95
    v_cvt_pk_bf16_f32 v40, v96, v97
    v_cvt_pk_bf16_f32 v41, v98, v99
    v_cvt_pk_bf16_f32 v42, v100, v101
    v_cvt_pk_bf16_f32 v43, v102, v103
    v_lshlrev_b32 v64, 16, v24
    v_and_b32 v65, 0xffff0000, v24
    v_lshlrev_b32 v66, 16, v25
    v_and_b32 v67, 0xffff0000, v25
    v_lshlrev_b32 v68, 16, v26
    v_and_b32 v69, 0xffff0000, v26
    v_lshlrev_b32 v70, 16, v27
    v_and_b32 v71, 0xffff0000, v27
    v_lshlrev_b32 v72, 16, v28
    v_and_b32 v73, 0xffff0000, v28
    v_lshlrev_b32 v74, 16, v29
    v_and_b32 v75, 0xffff0000, v29
    v_lshlrev_b32 v76, 16, v30
    v_and_b32 v77, 0xffff0000, v30
    v_lshlrev_b32 v78, 16, v31
    v_and_b32 v79, 0xffff0000, v31
    v_lshlrev_b32 v80, 16, v32
    v_and_b32 v81, 0xffff0000, v32
    v_lshlrev_b32 v82, 16, v33
    v_and_b32 v83, 0xffff0000, v33
    v_lshlrev_b32 v84, 16, v34
    v_and_b32 v85, 0xffff0000, v34
    v_lshlrev_b32 v86, 16, v35
    v_and_b32 v87, 0xffff0000, v35
    v_lshlrev_b32 v88, 16, v36
    v_and_b32 v89, 0xffff0000, v36
    v_lshlrev_b32 v90, 16, v37
    v_and_b32 v91, 0xffff0000, v37
    v_lshlrev_b32 v92, 16, v38
    v_and_b32 v93, 0xffff0000, v38
    v_lshlrev_b32 v94, 16, v39
    v_and_b32 v95, 0xffff0000, v39
    v_lshlrev_b32 v96, 16, v40
    v_and_b32 v97, 0xffff0000, v40
    v_lshlrev_b32 v98, 16, v41
    v_and_b32 v99, 0xffff0000, v41
    v_lshlrev_b32 v100, 16, v42
    v_and_b32 v101, 0xffff0000, v42
    v_lshlrev_b32 v102, 16, v43
    v_and_b32 v103, 0xffff0000, v43
    v_pk_mul_f32 v[64:65], v[64:65], v[110:111] op_sel:[0,1] op_sel_hi:[1,1]
    v_pk_mul_f32 v[66:67], v[66:67], v[110:111] op_sel:[0,1] op_sel_hi:[1,1]
    v_pk_mul_f32 v[68:69], v[68:69], v[110:111] op_sel:[0,1] op_sel_hi:[1,1]
    v_pk_mul_f32 v[70:71], v[70:71], v[110:111] op_sel:[0,1] op_sel_hi:[1,1]
    v_pk_mul_f32 v[72:73], v[72:73], v[110:111] op_sel:[0,1] op_sel_hi:[1,1]
    v_pk_mul_f32 v[74:75], v[74:75], v[110:111] op_sel:[0,1] op_sel_hi:[1,1]
    v_pk_mul_f32 v[76:77], v[76:77], v[110:111] op_sel:[0,1] op_sel_hi:[1,1]
    v_pk_mul_f32 v[78:79], v[78:79], v[110:111] op_sel:[0,1] op_sel_hi:[1,1]
    v_pk_mul_f32 v[80:81], v[80:81], v[110:111] op_sel:[0,1] op_sel_hi:[1,1]
    v_pk_mul_f32 v[82:83], v[82:83], v[110:111] op_sel:[0,1] op_sel_hi:[1,1]
    v_pk_mul_f32 v[84:85], v[84:85], v[110:111] op_sel:[0,1] op_sel_hi:[1,1]
    v_pk_mul_f32 v[86:87], v[86:87], v[110:111] op_sel:[0,1] op_sel_hi:[1,1]
    v_pk_mul_f32 v[88:89], v[88:89], v[110:111] op_sel:[0,1] op_sel_hi:[1,1]
    v_pk_mul_f32 v[90:91], v[90:91], v[110:111] op_sel:[0,1] op_sel_hi:[1,1]
    v_pk_mul_f32 v[92:93], v[92:93], v[110:111] op_sel:[0,1] op_sel_hi:[1,1]
    v_pk_mul_f32 v[94:95], v[94:95], v[110:111] op_sel:[0,1] op_sel_hi:[1,1]
    v_pk_mul_f32 v[96:97], v[96:97], v[110:111] op_sel:[0,1] op_sel_hi:[1,1]
    v_pk_mul_f32 v[98:99], v[98:99], v[110:111] op_sel:[0,1] op_sel_hi:[1,1]
    v_pk_mul_f32 v[100:101], v[100:101], v[110:111] op_sel:[0,1] op_sel_hi:[1,1]
    v_pk_mul_f32 v[102:103], v[102:103], v[110:111] op_sel:[0,1] op_sel_hi:[1,1]
    v_cvt_pk_bf16_f32 v24, v64, v65
    v_cvt_pk_bf16_f32 v25, v66, v67
    v_cvt_pk_bf16_f32 v26, v68, v69
    v_cvt_pk_bf16_f32 v27, v70, v71
    v_cvt_pk_bf16_f32 v28, v72, v73
    v_cvt_pk_bf16_f32 v29, v74, v75
    v_cvt_pk_bf16_f32 v30, v76, v77
    v_cvt_pk_bf16_f32 v31, v78, v79
    v_cvt_pk_bf16_f32 v32, v80, v81
    v_cvt_pk_bf16_f32 v33, v82, v83
    v_cvt_pk_bf16_f32 v34, v84, v85
    v_cvt_pk_bf16_f32 v35, v86, v87
    v_cvt_pk_bf16_f32 v36, v88, v89
    v_cvt_pk_bf16_f32 v37, v90, v91
    v_cvt_pk_bf16_f32 v38, v92, v93
    v_cvt_pk_bf16_f32 v39, v94, v95
    v_cvt_pk_bf16_f32 v40, v96, v97
    v_cvt_pk_bf16_f32 v41, v98, v99
    v_cvt_pk_bf16_f32 v42, v100, v101
    v_cvt_pk_bf16_f32 v43, v102, v103
    v_dot2c_f32_bf16 v113, v24, v44
    v_dot2c_f32_bf16 v113, v25, v45
    v_dot2c_f32_bf16 v113, v26, v46
    v_dot2c_f32_bf16 v113, v27, v47
    v_dot2c_f32_bf16 v113, v28, v48
    v_dot2c_f32_bf16 v113, v29, v49
    v_dot2c_f32_bf16 v113, v30, v50
    v_dot2c_f32_bf16 v113, v31, v51
    v_dot2c_f32_bf16 v113, v32, v52
    v_dot2c_f32_bf16 v113, v33, v53
    v_dot2c_f32_bf16 v113, v34, v54
    v_dot2c_f32_bf16 v113, v35, v55
    v_dot2c_f32_bf16 v113, v36, v56
    v_dot2c_f32_bf16 v113, v37, v57
    v_dot2c_f32_bf16 v113, v38, v58
    v_dot2c_f32_bf16 v113, v39, v59
    v_dot2c_f32_bf16 v113, v40, v60
    v_dot2c_f32_bf16 v113, v41, v61
    v_dot2c_f32_bf16 v113, v42, v62
    v_dot2c_f32_bf16 v113, v43, v63
    s_nop 2
    s_nop 0
    v_add_f32_dpp v112, v112, v112 quad_perm:[1,0,3,2] row_mask:0xf bank_mask:0xf
    v_add_f32_dpp v113, v113, v113 quad_perm:[1,0,3,2] row_mask:0xf bank_mask:0xf
    s_nop 0
    v_add_f32_dpp v112, v112, v112 quad_perm:[2,3,0,1] row_mask:0xf bank_mask:0xf
    v_add_f32_dpp v113, v113, v113 quad_perm:[2,3,0,1] row_mask:0xf bank_mask:0xf
    s_nop 0
    v_add_f32_dpp v112, v112, v112 row_half_mirror row_mask:0xf bank_mask:0xf
    v_add_f32_dpp v113, v113, v113 row_half_mirror row_mask:0xf bank_mask:0xf
    s_nop 0
    v_add_f32_dpp v112, v112, v112 row_mirror row_mask:0xf bank_mask:0xf
    v_add_f32_dpp v113, v113, v113 row_mirror row_mask:0xf bank_mask:0xf
    v_cndmask_b32 v112, v112, v113, s[32:33]
    v_cvt_pk_bf16_f32 v112, v112, v112
    v_and_b32 v112, 0xffff0000, v112
    v_ashrrev_i32 v117, 31, v112
    v_or_b32 v117, 0x80000000, v117
    v_xor_b32 v112, v112, v117
    v_and_b32 v112, 0xffff0000, v112
    v_sub_u32 v117, 0xffff, v118
    v_or_b32 v112, v112, v117
    s_mov_b32 s49, 0xb08000
    s_mov_b64 exec, s[34:35]
    buffer_store_dword v112, v119, s[16:19], s49 offen sc1
    s_mov_b64 exec, -1
    v_mov_b32 v117, 1
    s_waitcnt vmcnt(0)
    s_mov_b64 exec, 1
    ds_add_rtn_u32 v116, v3, v117 offset:8
    s_waitcnt lgkmcnt(0)
    v_readfirstlane_b32 s38, v116
    v_mov_b32 v116, 64
    s_cmp_eq_u32 s38, 3
    s_mov_b32 s38, 0
    s_cbranch_scc0 LS_xn
    buffer_atomic_add v117, v116, s[44:47], 0 offen sc0 sc1
    s_mov_b32 s38, 1
LS_xn:
    s_mov_b64 exec, -1
    s_mov_b32 s39, 0xd81400
    s_mov_b32 s49, 0xd80000
    buffer_store_dwordx4 v[4:7], v114, s[16:19], s49 offen offset:0 sc1
    buffer_store_dwordx4 v[8:11], v114, s[16:19], s49 offen offset:256 sc1
    buffer_store_dwordx4 v[12:15], v114, s[16:19], s49 offen offset:512 sc1
    buffer_store_dwordx4 v[16:19], v114, s[16:19], s49 offen offset:768 sc1
    buffer_store_dwordx4 v[20:23], v114, s[16:19], s49 offen offset:1024 sc1
    buffer_store_dwordx4 v[24:27], v114, s[16:19], s39 offen offset:0 sc1
    buffer_store_dwordx4 v[28:31], v114, s[16:19], s39 offen offset:256 sc1
    buffer_store_dwordx4 v[32:35], v114, s[16:19], s39 offen offset:512 sc1
    buffer_store_dwordx4 v[36:39], v114, s[16:19], s39 offen offset:768 sc1
    buffer_store_dwordx4 v[40:43], v114, s[16:19], s39 offen offset:1024 sc1
    s_cmp_eq_u32 s38, 0
    s_cbranch_scc1 LS_rdone
    s_waitcnt vmcnt(10)
    v_readfirstlane_b32 s38, v117
    s_cmp_lg_u32 s38, 63
    s_cbranch_scc1 LS_rdone
    s_mov_b64 exec, -1
    v_lshlrev_b32 v115, 4, v0
    s_mov_b32 s38, 0xb08000
    s_mov_b32 s39, 0xb09000
    buffer_load_dwordx4 v[64:67], v115, s[16:19], s38 offen offset:0 sc1
    buffer_load_dwordx4 v[68:71], v115, s[16:19], s38 offen offset:1024 sc1
    buffer_load_dwordx4 v[72:75], v115, s[16:19], s38 offen offset:2048 sc1
    buffer_load_dwordx4 v[76:79], v115, s[16:19], s38 offen offset:3072 sc1
    buffer_load_dwordx4 v[80:83], v115, s[16:19], s39 offen offset:0 sc1
    buffer_load_dwordx4 v[84:87], v115, s[16:19], s39 offen offset:1024 sc1
    buffer_load_dwordx4 v[88:91], v115, s[16:19], s39 offen offset:2048 sc1
    buffer_load_dwordx4 v[92:95], v115, s[16:19], s39 offen offset:3072 sc1
    s_mov_b32 s39, 0
    v_mov_b32 v119, 0
    s_waitcnt vmcnt(0)
LS_top2:
    v_max_u32 v96, v64, v65
    v_min_u32 v100, v64, v65
    v_max_u32 v97, v72, v73
    v_min_u32 v101, v72, v73
    v_max_u32 v98, v80, v81
    v_min_u32 v102, v80, v81
    v_max_u32 v99, v88, v89
    v_min_u32 v103, v88, v89
    v_med3_u32 v100, v96, v100, v66
    v_max_u32 v96, v96, v66
    v_med3_u32 v101, v97, v101, v74
    v_max_u32 v97, v97, v74
    v_med3_u32 v102, v98, v102, v82
    v_max_u32 v98, v98, v82
    v_med3_u32 v103, v99, v103, v90
    v_max_u32 v99, v99, v90
    v_med3_u32 v100, v96, v100, v67
    v_max_u32 v96, v96, v67
    v_med3_u32 v101, v97, v101, v75
    v_max_u32 v97, v97, v75
    v_med3_u32 v102, v98, v102, v83
    v_max_u32 v98, v98, v83
    v_med3_u32 v103, v99, v103, v91
    v_max_u32 v99, v99, v91
    v_med3_u32 v100, v96, v100, v68
    v_max_u32 v96, v96, v68
    v_med3_u32 v101, v97, v101, v76
    v_max_u32 v97, v97, v76
    v_med3_u32 v102, v98, v102, v84
    v_max_u32 v98, v98, v84
    v_med3_u32 v103, v99, v103, v92
    v_max_u32 v99, v99, v92
    v_med3_u32 v100, v96, v100, v69
    v_max_u32 v96, v96, v69
    v_med3_u32 v101, v97, v101, v77
    v_max_u32 v97, v97, v77
    v_med3_u32 v102, v98, v102, v85
    v_max_u32 v98, v98, v85
    v_med3_u32 v103, v99, v103, v93
    v_max_u32 v99, v99, v93
    v_med3_u32 v100, v96, v100, v70
    v_max_u32 v96, v96, v70
    v_med3_u32 v101, v97, v101, v78
    v_max_u32 v97, v97, v78
    v_med3_u32 v102, v98, v102, v86
    v_max_u32 v98, v98, v86
    v_med3_u32 v103, v99, v103, v94
    v_max_u32 v99, v99, v94
    v_med3_u32 v100, v96, v100, v71
    v_max_u32 v96, v96, v71
    v_med3_u32 v101, v97, v101, v79
    v_max_u32 v97, v97, v79
    v_med3_u32 v102, v98, v102, v87
    v_max_u32 v98, v98, v87
    v_med3_u32 v103, v99, v103, v95
    v_max_u32 v99, v99, v95
    v_min_u32 v104, v96, v97
    v_max_u32 v96, v96, v97
    v_max3_u32 v100, v104, v100, v101
    v_min_u32 v104, v98, v99
    v_max_u32 v98, v98, v99
    v_max3_u32 v102, v104, v102, v103
    v_min_u32 v104, v96, v98
    v_max_u32 v96, v96, v98
    v_max3_u32 v100, v104, v100, v102
LS_top:
    s_nop 1
    v_max_u32_dpp v104, v96, v96 quad_perm:[1,0,3,2] row_mask:0xf bank_mask:0xf
    s_nop 1
    v_max_u32_dpp v104, v104, v104 quad_perm:[2,3,0,1] row_mask:0xf bank_mask:0xf
    s_nop 1
    v_max_u32_dpp v104, v104, v104 row_half_mirror row_mask:0xf bank_mask:0xf
    s_nop 1
    v_max_u32_dpp v104, v104, v104 row_mirror row_mask:0xf bank_mask:0xf
    s_nop 1
    v_max_u32_dpp v104, v104, v104 row_bcast:15 row_mask:0xa bank_mask:0xf
    s_nop 1
    v_max_u32_dpp v104, v104, v104 row_bcast:31 row_mask:0xc bank_mask:0xf
    s_mov_b32 m0, s39
    v_readlane_b32 s49, v104, 63
    s_add_u32 s39, s39, 1
    s_cmp_lt_u32 s39, 8
    v_cmp_eq_u32 vcc, s49, v96
    v_writelane_b32 v119, s49, m0
    s_cbranch_scc0 LS_topd
    v_cndmask_b32 v96, v96, v100, vcc
    v_cndmask_b32 v100, v100, 0, vcc
    v_cmp_eq_u32 vcc, 0, v96
    s_cbranch_vccz LS_top
    v_cmp_gt_u32 s[24:25], s49, v64
    v_cmp_gt_u32 s[26:27], s49, v65
    v_cmp_gt_u32 s[28:29], s49, v66
    v_cmp_gt_u32 s[30:31], s49, v67
    v_cndmask_b32 v64, 0, v64, s[24:25]
    v_cndmask_b32 v65, 0, v65, s[26:27]
    v_cndmask_b32 v66, 0, v66, s[28:29]
    v_cndmask_b32 v67, 0, v67, s[30:31]
    v_cmp_gt_u32 s[24:25], s49, v68
    v_cmp_gt_u32 s[26:27], s49, v69
    v_cmp_gt_u32 s[28:29], s49, v70
    v_cmp_gt_u32 s[30:31], s49, v71
    v_cndmask_b32 v68, 0, v68, s[24:25]
    v_cndmask_b32 v69, 0, v69, s[26:27]
    v_cndmask_b32 v70, 0, v70, s[28:29]
    v_cndmask_b32 v71, 0, v71, s[30:31]
    v_cmp_gt_u32 s[24:25], s49, v72
    v_cmp_gt_u32 s[26:27], s49, v73
    v_cmp_gt_u32 s[28:29], s49, v74
    v_cmp_gt_u32 s[30:31], s49, v75
    v_cndmask_b32 v72, 0, v72, s[24:25]
    v_cndmask_b32 v73, 0, v73, s[26:27]
    v_cndmask_b32 v74, 0, v74, s[28:29]
    v_cndmask_b32 v75, 0, v75, s[30:31]
    v_cmp_gt_u32 s[24:25], s49, v76
    v_cmp_gt_u32 s[26:27], s49, v77
    v_cmp_gt_u32 s[28:29], s49, v78
    v_cmp_gt_u32 s[30:31], s49, v79
    v_cndmask_b32 v76, 0, v76, s[24:25]
    v_cndmask_b32 v77, 0, v77, s[26:27]
    v_cndmask_b32 v78, 0, v78, s[28:29]
    v_cndmask_b32 v79, 0, v79, s[30:31]
    v_cmp_gt_u32 s[24:25], s49, v80
    v_cmp_gt_u32 s[26:27], s49, v81
    v_cmp_gt_u32 s[28:29], s49, v82
    v_cmp_gt_u32 s[30:31], s49, v83
    v_cndmask_b32 v80, 0, v80, s[24:25]
    v_cndmask_b32 v81, 0, v81, s[26:27]
    v_cndmask_b32 v82, 0, v82, s[28:29]
    v_cndmask_b32 v83, 0, v83, s[30:31]
    v_cmp_gt_u32 s[24:25], s49, v84
    v_cmp_gt_u32 s[26:27], s49, v85
    v_cmp_gt_u32 s[28:29], s49, v86
    v_cmp_gt_u32 s[30:31], s49, v87
    v_cndmask_b32 v84, 0, v84, s[24:25]
    v_cndmask_b32 v85, 0, v85, s[26:27]
    v_cndmask_b32 v86, 0, v86, s[28:29]
    v_cndmask_b32 v87, 0, v87, s[30:31]
    v_cmp_gt_u32 s[24:25], s49, v88
    v_cmp_gt_u32 s[26:27], s49, v89
    v_cmp_gt_u32 s[28:29], s49, v90
    v_cmp_gt_u32 s[30:31], s49, v91
    v_cndmask_b32 v88, 0, v88, s[24:25]
    v_cndmask_b32 v89, 0, v89, s[26:27]
    v_cndmask_b32 v90, 0, v90, s[28:29]
    v_cndmask_b32 v91, 0, v91, s[30:31]
    v_cmp_gt_u32 s[24:25], s49, v92
    v_cmp_gt_u32 s[26:27], s49, v93
    v_cmp_gt_u32 s[28:29], s49, v94
    v_cmp_gt_u32 s[30:31], s49, v95
    v_cndmask_b32 v92, 0, v92, s[24:25]
    v_cndmask_b32 v93, 0, v93, s[26:27]
    v_cndmask_b32 v94, 0, v94, s[28:29]
    v_cndmask_b32 v95, 0, v95, s[30:31]
    s_branch LS_top2
LS_topd:
    v_mov_b32 v114, v119
    v_and_b32 v116, 0xffff, v114
    v_sub_u32 v116, 0xffff, v116
    v_and_b32 v116, 0x7ff, v116
    v_lshlrev_b32 v115, 2, v0
    s_mov_b64 exec, 0xff
    v_ashrrev_i32 v117, 31, v114
    v_not_b32 v117, v117
    v_or_b32 v117, 0x80000000, v117
    v_xor_b32 v114, v114, v117
    v_and_b32 v114, 0xffff0000, v114
    v_mul_f32 v114, 0xbfb8aa3b, v114
    v_exp_f32 v114, v114
    s_mov_b32 s38, 0xb0a000
    v_add_f32 v114, 1.0, v114
    v_rcp_f32 v114, v114
    buffer_store_dword v116, v115, s[16:19], s38 offen sc1
    v_cvt_pk_bf16_f32 v114, v114, v114
    v_and_b32 v114, 0xffff0000, v114
    buffer_store_dword v114, v115, s[16:19], s38 offen offset:32 sc1
LS_rdone:
    s_mov_b64 exec, -1
    s_waitcnt vmcnt(0)
    s_endpgm
LS_cw:
    s_setprio 2
    s_sub_u32 s48, s20, 4
    s_lshr_b32 s38, s21, 1
    s_lshl_b32 s38, s38, 3
    s_add_u32 s38, s38, s22
    s_min_u32 s38, s38, 29
    s_and_b32 s35, s38, 1
    s_lshr_b32 s38, s38, 1
    s_lshl_b32 s38, s38, 7
    s_and_b32 s39, s21, 1
    s_mul_i32 s39, s39, 1920
    s_add_u32 s23, s38, s39
    s_lshl_b32 s39, s35, 2
    s_add_u32 s39, s39, s48
    s_mul_i32 s39, s39, 307200
    s_add_u32 s38, s23, s39
    v_lshrrev_b32 v116, 3, v0
    v_and_b32 v117, 7, v0
    v_lshlrev_b32 v117, 4, v117
    v_mul_u32_u24 v114, 3840, v116
    v_add_u32 v114, v114, v117
    s_waitcnt lgkmcnt(0)
    s_mov_b32 s12, s6
    s_mov_b32 s13, s7
    s_mov_b32 s14, 0x258000
    s_mov_b32 s15, 0x20000
    buffer_load_dwordx4 v[4:7], v114, s[12:15], s38 offen
    s_add_u32 s38, s38, 30720
    buffer_load_dwordx4 v[8:11], v114, s[12:15], s38 offen
    s_add_u32 s38, s38, 30720
    buffer_load_dwordx4 v[12:15], v114, s[12:15], s38 offen
    s_add_u32 s38, s38, 30720
    buffer_load_dwordx4 v[16:19], v114, s[12:15], s38 offen
    s_add_u32 s38, s38, 30720
    buffer_load_dwordx4 v[20:23], v114, s[12:15], s38 offen
    s_add_u32 s38, s38, 30720
    buffer_load_dwordx4 v[24:27], v114, s[12:15], s38 offen
    s_add_u32 s38, s38, 30720
    buffer_load_dwordx4 v[28:31], v114, s[12:15], s38 offen
    s_add_u32 s38, s38, 30720
    buffer_load_dwordx4 v[32:35], v114, s[12:15], s38 offen
    s_add_u32 s38, s38, 30720
    buffer_load_dwordx4 v[36:39], v114, s[12:15], s38 offen
    s_add_u32 s38, s38, 30720
    buffer_load_dwordx4 v[40:43], v114, s[12:15], s38 offen
    s_mov_b32 s16, s42
    s_mov_b32 s17, s43
    s_mov_b32 s18, 0x1100000
    s_mov_b32 s19, 0x20000
    s_mov_b32 s24, s78
    s_mov_b32 s25, s79
    s_mov_b32 s26, 0xc8000
    s_mov_b32 s27, 0x20000
    s_cmp_lg_u32 s48, 0
    s_cselect_b32 s34, 0x40000, 0
    v_add_u32 v118, s34, v0
    s_getpc_b64 s[44:45]
Lpc_1987:
    s_add_u32 s44, s44, L1_spare-Lpc_1987
    s_addc_u32 s45, s45, ((L1_spare-Lpc_1987)>>32)
    s_mov_b32 s46, L1_end-L1_spare
    s_mov_b32 s47, 0x20000
    v_lshlrev_b32 v116, 7, v118
    buffer_load_dword v119, v116, s[44:47], 0 offen
    s_cmp_ge_u32 s22, 2
    s_cselect_b32 s34, 0x40000, s34
    s_lshl_b32 s33, s22, 6
    s_add_u32 s34, s34, s33
    v_add_u32 v118, s34, v0
    s_getpc_b64 s[44:45]
Lpc_2000:
    s_add_u32 s44, s44, L1_end-Lpc_2000
    s_addc_u32 s45, s45, ((L1_end-Lpc_2000)>>32)
    s_mov_b32 s46, L_code_end-L1_end
    s_mov_b32 s47, 0x20000
    v_lshlrev_b32 v116, 7, v118
    buffer_load_dword v119, v116, s[44:47], 0 offen
    s_mov_b32 s44, s40
    s_mov_b32 s45, s41
    s_mov_b32 s46, 0x100
    s_mov_b32 s47, 0x20000
    s_lshl_b32 s34, s48, 6
    v_add_u32 v118, s34, v0
    v_lshlrev_b32 v116, 21, v118
    v_mov_b32 v117, 0
    buffer_load_dword v119, v116, s[16:19], 0 offen
    buffer_load_dword v119, v116, s[24:27], 0 offen
    buffer_atomic_add v117, v116, s[44:47], 0 offen offset:32 sc1
    s_barrier
    s_cmp_ge_u32 s2, 40
    s_cbranch_scc1 LS_noclr
    v_mov_b32 v44, 0
    v_mov_b32 v45, 0
    v_mov_b32 v46, 0
    v_mov_b32 v47, 0
    s_lshl_b32 s38, s2, 2
    s_add_u32 s38, s38, s48
    s_lshl_b32 s38, s38, 10
    s_add_u32 s38, s38, 0xd00000
    v_lshlrev_b32 v117, 4, v0
    buffer_store_dwordx4 v[44:47], v117, s[16:19], s38 offen sc1
LS_noclr:
    s_sub_u32 s38, s2, 40
    s_cmp_ge_u32 s38, 3
    s_cbranch_scc1 LS_noclr2
    s_lshl_b32 s38, s38, 2
    s_add_u32 s38, s38, s48
    s_lshl_b32 s38, s38, 13
    s_add_u32 s38, s38, 0xc00000
    v_lshlrev_b32 v117, 7, v0
    v_mov_b32 v44, 0
    v_mov_b32 v45, 0
    v_mov_b32 v46, 0
    v_mov_b32 v47, 0
    buffer_store_dwordx4 v[44:47], v117, s[16:19], s38 offen sc1
LS_noclr2:
    s_waitcnt vmcnt(5)
LS_cs:
    v_lshlrev_b32 v44, 16, v4
    v_and_b32 v45, 0xffff0000, v4
    v_lshlrev_b32 v46, 16, v5
    v_and_b32 v47, 0xffff0000, v5
    v_lshlrev_b32 v48, 16, v6
    v_and_b32 v49, 0xffff0000, v6
    v_lshlrev_b32 v50, 16, v7
    v_and_b32 v51, 0xffff0000, v7
    v_lshlrev_b32 v64, 16, v8
    v_and_b32 v65, 0xffff0000, v8
    v_lshlrev_b32 v66, 16, v9
    v_and_b32 v67, 0xffff0000, v9
    v_lshlrev_b32 v68, 16, v10
    v_and_b32 v69, 0xffff0000, v10
    v_lshlrev_b32 v70, 16, v11
    v_and_b32 v71, 0xffff0000, v11
    v_pk_add_f32 v[44:45], v[44:45], v[64:65]
    v_pk_add_f32 v[46:47], v[46:47], v[66:67]
    v_pk_add_f32 v[48:49], v[48:49], v[68:69]
    v_pk_add_f32 v[50:51], v[50:51], v[70:71]
    v_lshlrev_b32 v64, 16, v12
    v_and_b32 v65, 0xffff0000, v12
    v_lshlrev_b32 v66, 16, v13
    v_and_b32 v67, 0xffff0000, v13
    v_lshlrev_b32 v68, 16, v14
    v_and_b32 v69, 0xffff0000, v14
    v_lshlrev_b32 v70, 16, v15
    v_and_b32 v71, 0xffff0000, v15
    v_pk_add_f32 v[44:45], v[44:45], v[64:65]
    v_pk_add_f32 v[46:47], v[46:47], v[66:67]
    v_pk_add_f32 v[48:49], v[48:49], v[68:69]
    v_pk_add_f32 v[50:51], v[50:51], v[70:71]
    v_lshlrev_b32 v64, 16, v16
    v_and_b32 v65, 0xffff0000, v16
    v_lshlrev_b32 v66, 16, v17
    v_and_b32 v67, 0xffff0000, v17
    v_lshlrev_b32 v68, 16, v18
    v_and_b32 v69, 0xffff0000, v18
    v_lshlrev_b32 v70, 16, v19
    v_and_b32 v71, 0xffff0000, v19
    v_pk_add_f32 v[44:45], v[44:45], v[64:65]
    v_pk_add_f32 v[46:47], v[46:47], v[66:67]
    v_pk_add_f32 v[48:49], v[48:49], v[68:69]
    v_pk_add_f32 v[50:51], v[50:51], v[70:71]
    v_lshlrev_b32 v64, 16, v20
    v_and_b32 v65, 0xffff0000, v20
    v_lshlrev_b32 v66, 16, v21
    v_and_b32 v67, 0xffff0000, v21
    v_lshlrev_b32 v68, 16, v22
    v_and_b32 v69, 0xffff0000, v22
    v_lshlrev_b32 v70, 16, v23
    v_and_b32 v71, 0xffff0000, v23
    v_pk_add_f32 v[44:45], v[44:45], v[64:65]
    v_pk_add_f32 v[46:47], v[46:47], v[66:67]
    v_pk_add_f32 v[48:49], v[48:49], v[68:69]
    v_pk_add_f32 v[50:51], v[50:51], v[70:71]
    v_lshlrev_b32 v64, 16, v24
    v_and_b32 v65, 0xffff0000, v24
    v_lshlrev_b32 v66, 16, v25
    v_and_b32 v67, 0xffff0000, v25
    v_lshlrev_b32 v68, 16, v26
    v_and_b32 v69, 0xffff0000, v26
    v_lshlrev_b32 v70, 16, v27
    v_and_b32 v71, 0xffff0000, v27
    v_pk_add_f32 v[44:45], v[44:45], v[64:65]
    v_pk_add_f32 v[46:47], v[46:47], v[66:67]
    v_pk_add_f32 v[48:49], v[48:49], v[68:69]
    v_pk_add_f32 v[50:51], v[50:51], v[70:71]
    v_lshlrev_b32 v64, 16, v28
    v_and_b32 v65, 0xffff0000, v28
    v_lshlrev_b32 v66, 16, v29
    v_and_b32 v67, 0xffff0000, v29
    v_lshlrev_b32 v68, 16, v30
    v_and_b32 v69, 0xffff0000, v30
    v_lshlrev_b32 v70, 16, v31
    v_and_b32 v71, 0xffff0000, v31
    v_pk_add_f32 v[44:45], v[44:45], v[64:65]
    v_pk_add_f32 v[46:47], v[46:47], v[66:67]
    v_pk_add_f32 v[48:49], v[48:49], v[68:69]
    v_pk_add_f32 v[50:51], v[50:51], v[70:71]
    v_lshlrev_b32 v64, 16, v32
    v_and_b32 v65, 0xffff0000, v32
    v_lshlrev_b32 v66, 16, v33
    v_and_b32 v67, 0xffff0000, v33
    v_lshlrev_b32 v68, 16, v34
    v_and_b32 v69, 0xffff0000, v34
    v_lshlrev_b32 v70, 16, v35
    v_and_b32 v71, 0xffff0000, v35
    v_pk_add_f32 v[44:45], v[44:45], v[64:65]
    v_pk_add_f32 v[46:47], v[46:47], v[66:67]
    v_pk_add_f32 v[48:49], v[48:49], v[68:69]
    v_pk_add_f32 v[50:51], v[50:51], v[70:71]
    v_lshlrev_b32 v64, 16, v36
    v_and_b32 v65, 0xffff0000, v36
    v_lshlrev_b32 v66, 16, v37
    v_and_b32 v67, 0xffff0000, v37
    v_lshlrev_b32 v68, 16, v38
    v_and_b32 v69, 0xffff0000, v38
    v_lshlrev_b32 v70, 16, v39
    v_and_b32 v71, 0xffff0000, v39
    v_pk_add_f32 v[44:45], v[44:45], v[64:65]
    v_pk_add_f32 v[46:47], v[46:47], v[66:67]
    v_pk_add_f32 v[48:49], v[48:49], v[68:69]
    v_pk_add_f32 v[50:51], v[50:51], v[70:71]
    v_lshlrev_b32 v64, 16, v40
    v_and_b32 v65, 0xffff0000, v40
    v_lshlrev_b32 v66, 16, v41
    v_and_b32 v67, 0xffff0000, v41
    v_lshlrev_b32 v68, 16, v42
    v_and_b32 v69, 0xffff0000, v42
    v_lshlrev_b32 v70, 16, v43
    v_and_b32 v71, 0xffff0000, v43
    v_pk_add_f32 v[44:45], v[44:45], v[64:65]
    v_pk_add_f32 v[46:47], v[46:47], v[66:67]
    v_pk_add_f32 v[48:49], v[48:49], v[68:69]
    v_pk_add_f32 v[50:51], v[50:51], v[70:71]
    s_nop 0
    v_add_f32_dpp v44, v44, v44 row_ror:8 row_mask:0xf bank_mask:0xf
    v_add_f32_dpp v45, v45, v45 row_ror:8 row_mask:0xf bank_mask:0xf
    v_add_f32_dpp v46, v46, v46 row_ror:8 row_mask:0xf bank_mask:0xf
    v_add_f32_dpp v47, v47, v47 row_ror:8 row_mask:0xf bank_mask:0xf
    v_add_f32_dpp v48, v48, v48 row_ror:8 row_mask:0xf bank_mask:0xf
    v_add_f32_dpp v49, v49, v49 row_ror:8 row_mask:0xf bank_mask:0xf
    v_add_f32_dpp v50, v50, v50 row_ror:8 row_mask:0xf bank_mask:0xf
    v_add_f32_dpp v51, v51, v51 row_ror:8 row_mask:0xf bank_mask:0xf
    v_permlane32_swap_b32 v44, v48
    v_permlane32_swap_b32 v45, v49
    v_permlane32_swap_b32 v46, v50
    v_permlane32_swap_b32 v47, v51
    v_add_f32 v44, v44, v48
    v_add_f32 v45, v45, v49
    v_add_f32 v46, v46, v50
    v_add_f32 v47, v47, v51
    s_nop 0
    v_permlane16_swap_b32 v44, v46
    v_permlane16_swap_b32 v45, v47
    s_nop 0
    v_add_f32 v44, v44, v46
    v_add_f32 v45, v45, v47
    s_lshl_b32 s38, s48, 8
    s_add_u32 s38, s38, 65536
    v_and_b32 v116, 7, v0
    v_lshlrev_b32 v116, 5, v116
    v_lshrrev_b32 v117, 4, v0
    v_lshl_add_u32 v116, v117, 3, v116
    v_add_u32 v116, s38, v116
    v_mov_b32 v117, 1
    ds_write_b64 v116, v[44:45]
    s_mov_b64 exec, 1
    s_waitcnt vmcnt(0) lgkmcnt(0)
    ds_add_rtn_u32 v116, v3, v117
    s_mov_b64 exec, -1
    s_waitcnt lgkmcnt(0)
    v_readfirstlane_b32 s38, v116
    s_cmp_lg_u32 s38, 3
    s_cbranch_scc1 LS_cs_done
    v_lshlrev_b32 v116, 2, v0
    v_add_u32 v117, 65536, v116
    ds_read_b32 v64, v117 offset:0
    ds_read_b32 v65, v117 offset:256
    ds_read_b32 v66, v117 offset:512
    ds_read_b32 v67, v117 offset:768
    s_lshl_b32 s38, s23, 1
    s_mul_i32 s39, s35, 7680
    s_add_u32 s38, s38, s39
    s_add_u32 s38, s38, 0xb04000
    s_waitcnt lgkmcnt(0)
    v_add_f32 v64, v64, v65
    v_add_f32 v66, v66, v67
    v_add_f32 v64, v64, v66
    buffer_store_dword v64, v116, s[16:19], s38 offen sc1
    s_waitcnt vmcnt(0)
    v_mov_b32 v117, 1
    s_mov_b64 exec, 1
    ds_add_rtn_u32 v116, v3, v117 offset:4
    s_waitcnt lgkmcnt(0)
    v_readfirstlane_b32 s38, v116
    v_mov_b32 v116, 0
    s_cmp_lg_u32 s38, 4
    s_cbranch_scc1 LS_ns2221
    buffer_atomic_add v117, v116, s[44:47], 0 offen sc0 sc1
    s_waitcnt vmcnt(0)
    v_readfirstlane_b32 s38, v117
    v_mov_b32 v117, 64
    s_cmp_lg_u32 s38, 63
    s_cbranch_scc1 LS_ns2221
    buffer_store_dword v117, v116, s[44:47], 0 offen offset:128 sc1
LS_ns2221:
    s_mov_b64 exec, -1
LS_cs_done:
    s_cmp_lg_u32 s20, 7
    s_cbranch_scc1 LS_end
    s_setprio 0
    s_lshr_b32 s36, s2, 2
    s_and_b32 s48, s2, 3
    s_lshr_b32 s38, s36, 1
    s_mul_i32 s38, s38, 160
    s_and_b32 s39, s36, 1
    s_mul_i32 s39, s39, 409600
    s_add_u32 s38, s38, s39
    s_mul_i32 s39, s48, 102400
    s_add_u32 s38, s38, s39
    s_mov_b32 s39, 0
    s_movk_i32 s37, 1120
    v_lshlrev_b32 v117, 4, v0
    v_mul_u32_u24 v118, 6554, v0
    s_mov_b32 s49, 13
LS_wo_ld:
    v_lshrrev_b32 v116, 16, v118
    v_mad_u32_u24 v115, v116, s37, v117
    s_mov_b32 m0, s39
    v_add_u32 v118, 419456, v118
    s_cmp_eq_u32 s49, 1
    s_cselect_b32 exec_hi, 0, -1
    s_add_u32 s39, s39, 1024
    buffer_load_dwordx4 v115, s[24:27], s38 offen lds
    s_add_u32 s38, s38, 1024
    s_sub_u32 s49, s49, 1
    s_cmp_lg_u32 s49, 0
    s_cbranch_scc1 LS_wo_ld
    s_mov_b64 exec, -1
    v_bfe_u32 v116, v0, 4, 1
    v_bfe_u32 v117, v0, 2, 2
    v_mul_u32_u24 v118, 160, v117
    v_and_b32 v117, 3, v0
    v_mul_u32_u24 v117, 40, v117
    v_add_u32 v118, v118, v117
    v_lshrrev_b32 v117, 5, v0
    v_lshl_add_u32 v118, v117, 3, v118
    v_mul_u32_u24 v114, 6400, v116
    v_add_u32 v114, v114, v118
    v_mul_u32_u24 v116, 640, v116
    v_add_u32 v118, v118, v116
    v_and_b32 v115, 31, v0
    v_lshlrev_b32 v115, 4, v115
    v_lshl_add_u32 v115, v117, 10, v115
    s_lshr_b32 s36, s2, 3
    s_mul_i32 s36, s36, 102400
    s_add_u32 s36, s36, 0xa00000
    s_and_b32 s37, s2, 7
    s_mul_i32 s38, s37, 10240
    s_add_u32 s38, s38, s36
    s_lshr_b32 s39, s37, 1
    s_mul_i32 s39, s39, 5120
    s_and_b32 s37, s37, 1
    s_lshl_b32 s37, s37, 9
    s_add_u32 s39, s39, s37
    s_add_u32 s39, s39, s36
    s_add_u32 s39, s39, 81920
    s_waitcnt vmcnt(0)
    ds_read_b64_tr_b16 v[4:5], v118 offset:0
    ds_read_b64_tr_b16 v[6:7], v118 offset:1280
    ds_read_b64_tr_b16 v[8:9], v118 offset:16
    ds_read_b64_tr_b16 v[10:11], v118 offset:1296
    ds_read_b64_tr_b16 v[12:13], v118 offset:32
    ds_read_b64_tr_b16 v[14:15], v118 offset:1312
    s_add_u32 s37, s38, 4096
    s_waitcnt lgkmcnt(0)
    buffer_store_dwordx4 v[4:7], v115, s[16:19], s38 offen offset:0 sc1
    buffer_store_dwordx4 v[8:11], v115, s[16:19], s38 offen offset:2048 sc1
    s_mov_b32 exec_hi, 0
    buffer_store_dwordx4 v[12:15], v115, s[16:19], s37 offen offset:0 sc1
    s_mov_b64 exec, -1
    ds_read_b64_tr_b16 v[16:17], v118 offset:3200
    ds_read_b64_tr_b16 v[18:19], v118 offset:4480
    ds_read_b64_tr_b16 v[20:21], v118 offset:3216
    ds_read_b64_tr_b16 v[22:23], v118 offset:4496
    ds_read_b64_tr_b16 v[24:25], v118 offset:3232
    ds_read_b64_tr_b16 v[26:27], v118 offset:4512
    s_add_u32 s37, s38, 4096
    s_waitcnt lgkmcnt(0)
    buffer_store_dwordx4 v[16:19], v115, s[16:19], s38 offen offset:512 sc1
    buffer_store_dwordx4 v[20:23], v115, s[16:19], s38 offen offset:2560 sc1
    s_mov_b32 exec_hi, 0
    buffer_store_dwordx4 v[24:27], v115, s[16:19], s37 offen offset:512 sc1
    s_mov_b64 exec, -1
    ds_read_b64_tr_b16 v[28:29], v118 offset:6400
    ds_read_b64_tr_b16 v[30:31], v118 offset:7680
    ds_read_b64_tr_b16 v[32:33], v118 offset:6416
    ds_read_b64_tr_b16 v[34:35], v118 offset:7696
    ds_read_b64_tr_b16 v[36:37], v118 offset:6432
    ds_read_b64_tr_b16 v[38:39], v118 offset:7712
    s_add_u32 s38, s38, 5120
    s_add_u32 s37, s38, 4096
    s_waitcnt lgkmcnt(0)
    buffer_store_dwordx4 v[28:31], v115, s[16:19], s38 offen offset:0 sc1
    buffer_store_dwordx4 v[32:35], v115, s[16:19], s38 offen offset:2048 sc1
    s_mov_b32 exec_hi, 0
    buffer_store_dwordx4 v[36:39], v115, s[16:19], s37 offen offset:0 sc1
    s_mov_b64 exec, -1
    ds_read_b64_tr_b16 v[40:41], v118 offset:9600
    ds_read_b64_tr_b16 v[42:43], v118 offset:10880
    ds_read_b64_tr_b16 v[44:45], v118 offset:9616
    ds_read_b64_tr_b16 v[46:47], v118 offset:10896
    ds_read_b64_tr_b16 v[48:49], v118 offset:9632
    ds_read_b64_tr_b16 v[50:51], v118 offset:10912
    s_add_u32 s37, s38, 4096
    s_waitcnt lgkmcnt(0)
    buffer_store_dwordx4 v[40:43], v115, s[16:19], s38 offen offset:512 sc1
    buffer_store_dwordx4 v[44:47], v115, s[16:19], s38 offen offset:2560 sc1
    s_mov_b32 exec_hi, 0
    buffer_store_dwordx4 v[48:51], v115, s[16:19], s37 offen offset:512 sc1
    s_mov_b64 exec, -1
    ds_read_b64_tr_b16 v[52:53], v114 offset:2560
    ds_read_b64_tr_b16 v[54:55], v114 offset:5760
    ds_read_b64_tr_b16 v[56:57], v114 offset:2576
    ds_read_b64_tr_b16 v[58:59], v114 offset:5776
    ds_read_b64_tr_b16 v[60:61], v114 offset:2592
    ds_read_b64_tr_b16 v[62:63], v114 offset:5792
    s_mov_b32 s38, s39
    s_add_u32 s37, s38, 4096
    s_waitcnt lgkmcnt(0)
    buffer_store_dwordx4 v[52:55], v115, s[16:19], s38 offen offset:0 sc1
    buffer_store_dwordx4 v[56:59], v115, s[16:19], s38 offen offset:2048 sc1
    s_mov_b32 exec_hi, 0
    buffer_store_dwordx4 v[60:63], v115, s[16:19], s37 offen offset:0 sc1
    s_mov_b64 exec, -1
LS_end:
    s_waitcnt vmcnt(0)
    s_endpgm
L1_end:
    s_endpgm
.text
.globl attn_kernel
.p2align 8
.type attn_kernel,@function
attn_kernel:
    s_cmp_ge_u32 s2, 256
    s_cbranch_scc1 L2_end
    s_load_dwordx2 s[4:5], s[0:1], 80
    s_setprio 3
    v_lshrrev_b32 v164, 6, v0
    v_and_b32 v0, 63, v0
    s_and_b32 s16, s2, 7
    s_lshl_b32 s16, s16, 2
    s_bfe_u32 s28, s2, 0x20003
    s_add_u32 s16, s16, s28
    v_readfirstlane_b32 s18, v164
    s_mul_i32 s29, s16, 163840
    s_mov_b32 s10, 163840
    s_mov_b32 s11, 0x20000
    s_cmp_lt_u32 s18, 4
    s_cbranch_scc1 L2_helper
    s_lshr_b32 s17, s2, 5
    s_mov_b32 s20, 0x000fffff
    s_mov_b32 s21, 0x000fffff
    s_mov_b32 s22, 0
    s_mov_b32 s23, -1
    v_and_b32 v164, 31, v0
    v_lshrrev_b32 v165, 5, v0
    v_lshlrev_b32 v70, 4, v0
    v_and_b32 v71, 7, v0
    v_lshlrev_b32 v71, 4, v71
    v_and_b32 v166, 16, v0
    v_lshl_add_u32 v71, v166, 3, v71
    v_and_b32 v166, 8, v0
    v_add_u32 v71, v71, v166
    v_lshl_add_u32 v71, v165, 2, v71
    s_and_b32 s27, s18, 3
    s_lshr_b32 s26, s18, 3
    s_lshl_b32 s19, s17, 3
    s_lshl_b32 s28, s27, 1
    s_add_u32 s19, s19, s28
    s_mul_i32 s28, s16, 81920
    s_mul_i32 s30, s19, 1280
    s_add_u32 s28, s28, s30
    s_add_u32 s28, s28, 0x500000
    s_mul_i32 s31, s26, 81920
    s_waitcnt lgkmcnt(0)
    s_mov_b32 s12, s4
    s_mov_b32 s13, s5
    s_mov_b32 s14, 0x1100000
    s_mov_b32 s15, 0x20000
    s_mul_i32 s75, s26, 1280
    s_add_u32 s74, s28, s75
    s_sub_u32 s75, s28, s75
    s_add_u32 s75, s75, 1280
    buffer_load_dwordx4 v[4:7], v70, s[12:15], s74 offen offset:0
    buffer_load_dword v12, v71, s[12:15], s74 offen offset:1024
    buffer_load_dwordx4 v[8:11], v70, s[12:15], s75 offen offset:0
    buffer_load_dword v14, v71, s[12:15], s75 offen offset:1024
    s_add_u32 s8, s4, s29
    s_addc_u32 s9, s5, 0
    v_lshrrev_b32 v166, 2, v164
    v_add_u32 v72, v166, v165
    v_and_b32 v72, 3, v72
    v_lshlrev_b32 v72, 6, v72
    v_lshl_add_u32 v72, v166, 8, v72
    v_and_b32 v166, 3, v0
    v_lshl_add_u32 v72, v166, 4, v72
    v_add_u32 v70, s31, v70
    v_add_u32 v71, s31, v71
    v_add_u32 v72, s31, v72
    v_xor_b32 v73, 128, v72
    v_mov_b32 v21, 0x3f80
    v_mov_b32 v13, 0
    v_mov_b32 v15, 0
    v_mov_b32 v34, 0
    v_mov_b32 v35, 0
    v_mov_b32 v36, 0
    v_mov_b32 v37, 0
    v_mov_b32 v104, 0
    v_mov_b32 v105, 0
    v_mov_b32 v106, 0
    v_mov_b32 v107, 0
    v_mov_b32 v108, 0
    v_mov_b32 v109, 0
    v_mov_b32 v110, 0
    v_mov_b32 v111, 0
    v_mov_b32 v112, 0
    v_mov_b32 v113, 0
    v_mov_b32 v114, 0
    v_mov_b32 v115, 0
    v_mov_b32 v116, 0
    v_mov_b32 v117, 0
    v_mov_b32 v118, 0
    v_mov_b32 v119, 0
    v_mov_b32 v120, 0
    v_mov_b32 v121, 0
    v_mov_b32 v122, 0
    v_mov_b32 v123, 0
    v_mov_b32 v124, 0
    v_mov_b32 v125, 0
    v_mov_b32 v126, 0
    v_mov_b32 v127, 0
    v_mov_b32 v128, 0
    v_mov_b32 v129, 0
    v_mov_b32 v130, 0
    v_mov_b32 v131, 0
    v_mov_b32 v132, 0
    v_mov_b32 v133, 0
    v_mov_b32 v134, 0
    v_mov_b32 v135, 0
    v_mov_b32 v167, 0x3f803f80
    v_cmp_eq_u32 vcc, 20, v164
    v_cmp_eq_u32 s[32:33], 24, v164
    s_or_b64 vcc, vcc, s[32:33]
    s_mov_b32 s24, 0
    s_mov_b32 s25, 0
    v_cndmask_b32 v167, 0, v167, vcc
    v_mov_b32 v22, v167
    v_mov_b32 v23, v167
    v_mov_b32 v24, v167
    v_mov_b32 v25, v167
    v_mov_b32 v26, v167
    v_mov_b32 v27, v167
    v_mov_b32 v28, v167
    v_mov_b32 v29, v167
    s_and_b32 s70, s2, 7
    s_lshl_b32 s70, s70, 2
    s_lshr_b32 s28, s2, 6
    s_add_u32 s70, s70, s28
    s_bfe_u32 s71, s2, 0x30003
    s_lshl_b32 s72, s70, 2
    s_add_u32 s72, s72, s27
    s_lshl_b32 s56, s72, 14
    s_lshl_b32 s30, s26, 13
    s_add_u32 s56, s56, s30
    s_add_u32 s56, s56, 0x780000
    s_lshr_b32 s60, s72, 1
    s_lshl_b32 s60, s60, 13
    s_and_b32 s28, s72, 1
    s_lshl_b32 s28, s28, 7
    s_add_u32 s60, s60, s28
    s_lshl_b32 s30, s26, 12
    s_add_u32 s60, s60, s30
    s_add_u32 s60, s60, 0x980000
    s_cmp_eq_u32 s26, 0
    s_mov_b32 s68, 133120
    s_cselect_b32 s68, 122880, s68
    s_mov_b32 s69, 138240
    s_cselect_b32 s69, 128000, s69
    s_lshl_b32 s31, s26, 2
    s_add_u32 s28, s71, 3
    s_and_b32 s28, s28, 3
    s_lshl_b32 s29, s28, 11
    s_add_u32 s59, s56, s29
    s_add_u32 s28, s28, s31
    s_mul_i32 s29, s28, 10240
    s_cmp_ge_u32 s28, 5
    s_cselect_b32 s28, 29696, 0
    s_add_u32 s28, s28, s29
    s_add_u32 s67, s28, 11264
    s_add_u32 s28, s71, 2
    s_and_b32 s28, s28, 3
    s_lshl_b32 s29, s28, 11
    s_add_u32 s58, s56, s29
    s_add_u32 s28, s28, s31
    s_mul_i32 s29, s28, 10240
    s_cmp_ge_u32 s28, 5
    s_cselect_b32 s28, 29696, 0
    s_add_u32 s28, s28, s29
    s_add_u32 s66, s28, 11264
    s_add_u32 s28, s71, 1
    s_and_b32 s28, s28, 3
    s_lshl_b32 s29, s28, 11
    s_add_u32 s57, s56, s29
    s_add_u32 s28, s28, s31
    s_mul_i32 s29, s28, 10240
    s_cmp_ge_u32 s28, 5
    s_cselect_b32 s28, 29696, 0
    s_add_u32 s28, s28, s29
    s_add_u32 s65, s28, 11264
    s_add_u32 s28, s71, 0
    s_and_b32 s28, s28, 3
    s_lshl_b32 s29, s28, 11
    s_add_u32 s56, s56, s29
    s_add_u32 s28, s28, s31
    s_mul_i32 s29, s28, 10240
    s_cmp_ge_u32 s28, 5
    s_cselect_b32 s28, 29696, 0
    s_add_u32 s28, s28, s29
    s_add_u32 s64, s28, 11264
    v_lshlrev_b32 v1, 4, v0
    v_and_b32 v2, 15, v0
    v_lshrrev_b32 v3, 4, v0
    v_lshlrev_b32 v3, 9, v3
    v_lshl_add_u32 v3, v2, 3, v3
    v_bfe_u32 v165, v0, 4, 1
    v_and_b32 v166, 7, v0
    v_lshl_add_u32 v165, v165, 3, v166
    v_bfe_u32 v166, v0, 3, 1
    v_lshlrev_b32 v156, 14, v166
    v_lshl_add_u32 v156, v165, 4, v156
    v_lshlrev_b32 v157, 7, v166
    v_lshl_add_u32 v157, v165, 3, v157
    v_lshrrev_b32 v165, 5, v0
    v_lshl_add_u32 v156, v165, 8, v156
    s_add_u32 s19, s19, s26
    s_lshl_b32 s61, s19, 15
    s_lshl_b32 s29, s16, 9
    s_add_u32 s61, s61, s29
    s_lshl_b32 s62, s19, 13
    s_lshl_b32 s30, s16, 8
    s_add_u32 s62, s62, s30
    s_add_u32 s61, s61, 0x780000
    s_add_u32 s62, s62, 0x980000
    s_mul_i32 s28, s27, 7168
    s_add_u32 s28, s28, 62464
    v_and_b32 v155, 3, v0
    v_lshlrev_b32 v155, 3, v155
    v_bfe_u32 v165, v0, 2, 2
    v_add_u32 v155, v155, v165
    v_lshlrev_b32 v155, 7, v155
    s_lshr_b32 s63, s70, 2
    s_lshl_b32 s63, s63, 3
    s_add_u32 s63, s63, s26
    s_lshl_b32 s63, s63, 9
    s_add_u32 s63, s63, 0xc00004
    s_lshl_b32 s73, s2, 7
    s_add_u32 s73, s73, 0xc00004
    s_cmp_eq_u32 s18, 4
    s_cselect_b32 s73, s73, 0x7f000000
    s_mul_i32 s29, s26, 3584
    s_add_u32 s30, s28, s29
    s_sub_u32 s28, s28, s29
    s_add_u32 s28, s28, 3584
    v_lshl_add_u32 v158, v0, 4, s30
    v_lshl_add_u32 v159, v0, 4, s28
    v_lshl_add_u32 v160, v0, 3, s30
    v_lshl_add_u32 v161, v0, 3, s28
    s_barrier
    ds_read_b128 v[16:19], v70 offset:0
    ds_read_b32 v20, v71 offset:1024
    s_mov_b64 exec, s[20:21]
    ds_read_b128 v[22:25], v72 offset:1280
    s_mov_b64 exec, -1
    s_waitcnt vmcnt(0) lgkmcnt(1)
    v_mfma_f32_32x32x16_bf16 v[38:53], v[16:19], v[4:7], 0
    v_mfma_f32_32x32x8_bf16 v[38:53], v[20:21], v[12:13], v[38:53]
    v_mfma_f32_32x32x16_bf16 v[54:69], v[16:19], v[8:11], 0
    v_mfma_f32_32x32x8_bf16 v[54:69], v[20:21], v[14:15], v[54:69]
    s_nop 9
    v_max3_f32 v164, v38, v39, v40
    v_max3_f32 v165, v41, v42, v43
    v_max3_f32 v164, v164, v44, v45
    v_max3_f32 v165, v165, v46, v47
    v_max3_f32 v164, v164, v48, v49
    v_max3_f32 v165, v165, v50, v51
    v_max3_f32 v164, v164, v52, v53
    v_max_f32 v162, v164, v165
    v_mov_b32 v165, v162
    s_nop 1
    v_permlane32_swap_b32 v162, v165
    s_nop 1
    v_max_f32 v162, v162, v165
    v_and_b32 v164, 0xffff0000, v162
    v_sub_f32 v165, v162, v164
    v_and_b32 v165, 0xffff0000, v165
    v_add_f32 v162, v164, v165
    v_cndmask_b32 v164, v164, v165, s[22:23]
    v_xor_b32 v164, 0x80000000, v164
    v_lshrrev_b32 v13, 16, v164
    v_mfma_f32_32x32x16_bf16 v[38:53], v[16:19], v[4:7], 0
    s_nop 0
    v_mfma_f32_32x32x8_bf16 v[38:53], v[20:21], v[12:13], v[38:53]
    v_max3_f32 v164, v54, v55, v56
    v_max3_f32 v165, v57, v58, v59
    v_max3_f32 v164, v164, v60, v61
    v_max3_f32 v165, v165, v62, v63
    v_max3_f32 v164, v164, v64, v65
    v_max3_f32 v165, v165, v66, v67
    v_max3_f32 v164, v164, v68, v69
    v_max_f32 v163, v164, v165
    v_mov_b32 v165, v163
    s_nop 1
    v_permlane32_swap_b32 v163, v165
    s_nop 1
    v_max_f32 v163, v163, v165
    v_and_b32 v164, 0xffff0000, v163
    v_sub_f32 v165, v163, v164
    v_and_b32 v165, 0xffff0000, v165
    v_add_f32 v163, v164, v165
    v_cndmask_b32 v164, v164, v165, s[22:23]
    v_xor_b32 v164, 0x80000000, v164
    v_lshrrev_b32 v15, 16, v164
.p2align 6
L2_loop:
    v_mfma_f32_32x32x16_bf16 v[54:69], v[16:19], v[8:11], 0
    ds_read_b128 v[16:19], v70 offset:2560
    v_exp_f32 v38, v38
    v_exp_f32 v39, v39
    v_exp_f32 v40, v40
    v_exp_f32 v41, v41
    v_cvt_pk_bf16_f32 v30, v38, v39
    v_cvt_pk_bf16_f32 v31, v40, v41
    v_mfma_f32_32x32x16_bf16 v[120:135], v[26:29], v[34:37], v[120:135]
    s_mov_b64 exec, s[20:21]
    ds_read_b128 v[26:29], v73 offset:1280
    s_mov_b64 exec, -1
    v_exp_f32 v42, v42
    v_exp_f32 v43, v43
    v_exp_f32 v44, v44
    v_exp_f32 v45, v45
    v_cvt_pk_bf16_f32 v32, v42, v43
    v_cvt_pk_bf16_f32 v33, v44, v45
    v_mfma_f32_32x32x8_bf16 v[54:69], v[20:21], v[14:15], v[54:69]
    ds_read_b32 v20, v71 offset:3584
    v_exp_f32 v46, v46
    v_exp_f32 v47, v47
    v_exp_f32 v48, v48
    v_exp_f32 v49, v49
    v_cvt_pk_bf16_f32 v34, v46, v47
    v_cvt_pk_bf16_f32 v35, v48, v49
    s_waitcnt lgkmcnt(2)
    v_mfma_f32_32x32x16_bf16 v[104:119], v[22:25], v[30:33], v[104:119]
    v_exp_f32 v50, v50
    v_exp_f32 v51, v51
    v_exp_f32 v52, v52
    v_exp_f32 v53, v53
    v_cvt_pk_bf16_f32 v36, v50, v51
    v_cvt_pk_bf16_f32 v37, v52, v53
    v_mfma_f32_32x32x16_bf16 v[38:53], v[16:19], v[4:7], 0
    v_exp_f32 v54, v54
    v_exp_f32 v55, v55
    v_exp_f32 v56, v56
    v_exp_f32 v57, v57
    v_cvt_pk_bf16_f32 v30, v54, v55
    v_cvt_pk_bf16_f32 v31, v56, v57
    s_waitcnt lgkmcnt(0)
    v_mfma_f32_32x32x16_bf16 v[104:119], v[26:29], v[34:37], v[104:119]
    v_exp_f32 v58, v58
    v_exp_f32 v59, v59
    v_exp_f32 v60, v60
    v_exp_f32 v61, v61
    v_cvt_pk_bf16_f32 v32, v58, v59
    v_cvt_pk_bf16_f32 v33, v60, v61
    v_mfma_f32_32x32x8_bf16 v[38:53], v[20:21], v[12:13], v[38:53]
    v_exp_f32 v62, v62
    v_exp_f32 v63, v63
    v_exp_f32 v64, v64
    v_exp_f32 v65, v65
    v_cvt_pk_bf16_f32 v34, v62, v63
    v_cvt_pk_bf16_f32 v35, v64, v65
    v_mfma_f32_32x32x16_bf16 v[120:135], v[22:25], v[30:33], v[120:135]
    s_mov_b64 exec, s[20:21]
    ds_read_b128 v[22:25], v72 offset:3840
    s_mov_b64 exec, -1
    v_exp_f32 v66, v66
    v_exp_f32 v67, v67
    v_exp_f32 v68, v68
    v_exp_f32 v69, v69
    v_cvt_pk_bf16_f32 v36, v66, v67
    v_cvt_pk_bf16_f32 v37, v68, v69
    v_mfma_f32_32x32x16_bf16 v[54:69], v[16:19], v[8:11], 0
    ds_read_b128 v[16:19], v70 offset:5120
    v_exp_f32 v38, v38
    v_exp_f32 v39, v39
    v_exp_f32 v40, v40
    v_exp_f32 v41, v41
    v_cvt_pk_bf16_f32 v30, v38, v39
    v_cvt_pk_bf16_f32 v31, v40, v41
    v_mfma_f32_32x32x16_bf16 v[120:135], v[26:29], v[34:37], v[120:135]
    s_mov_b64 exec, s[20:21]
    ds_read_b128 v[26:29], v73 offset:3840
    s_mov_b64 exec, -1
    v_exp_f32 v42, v42
    v_exp_f32 v43, v43
    v_exp_f32 v44, v44
    v_exp_f32 v45, v45
    v_cvt_pk_bf16_f32 v32, v42, v43
    v_cvt_pk_bf16_f32 v33, v44, v45
    v_mfma_f32_32x32x8_bf16 v[54:69], v[20:21], v[14:15], v[54:69]
    ds_read_b32 v20, v71 offset:6144
    v_exp_f32 v46, v46
    v_exp_f32 v47, v47
    v_exp_f32 v48, v48
    v_exp_f32 v49, v49
    v_cvt_pk_bf16_f32 v34, v46, v47
    v_cvt_pk_bf16_f32 v35, v48, v49
    s_waitcnt lgkmcnt(2)
    v_mfma_f32_32x32x16_bf16 v[104:119], v[22:25], v[30:33], v[104:119]
    v_exp_f32 v50, v50
    v_exp_f32 v51, v51
    v_exp_f32 v52, v52
    v_exp_f32 v53, v53
    v_cvt_pk_bf16_f32 v36, v50, v51
    v_cvt_pk_bf16_f32 v37, v52, v53
    v_mfma_f32_32x32x16_bf16 v[38:53], v[16:19], v[4:7], 0
    v_exp_f32 v54, v54
    v_exp_f32 v55, v55
    v_exp_f32 v56, v56
    v_exp_f32 v57, v57
    v_cvt_pk_bf16_f32 v30, v54, v55
    v_cvt_pk_bf16_f32 v31, v56, v57
    s_waitcnt lgkmcnt(0)
    v_mfma_f32_32x32x16_bf16 v[104:119], v[26:29], v[34:37], v[104:119]
    v_exp_f32 v58, v58
    v_exp_f32 v59, v59
    v_exp_f32 v60, v60
    v_exp_f32 v61, v61
    v_cvt_pk_bf16_f32 v32, v58, v59
    v_cvt_pk_bf16_f32 v33, v60, v61
    v_mfma_f32_32x32x8_bf16 v[38:53], v[20:21], v[12:13], v[38:53]
    v_exp_f32 v62, v62
    v_exp_f32 v63, v63
    v_exp_f32 v64, v64
    v_exp_f32 v65, v65
    v_cvt_pk_bf16_f32 v34, v62, v63
    v_cvt_pk_bf16_f32 v35, v64, v65
    v_mfma_f32_32x32x16_bf16 v[120:135], v[22:25], v[30:33], v[120:135]
    s_mov_b64 exec, s[20:21]
    ds_read_b128 v[22:25], v72 offset:6400
    s_mov_b64 exec, -1
    v_exp_f32 v66, v66
    v_exp_f32 v67, v67
    v_exp_f32 v68, v68
    v_exp_f32 v69, v69
    v_cvt_pk_bf16_f32 v36, v66, v67
    v_cvt_pk_bf16_f32 v37, v68, v69
    v_mfma_f32_32x32x16_bf16 v[54:69], v[16:19], v[8:11], 0
    ds_read_b128 v[16:19], v70 offset:7680
    v_exp_f32 v38, v38
    v_exp_f32 v39, v39
    v_exp_f32 v40, v40
    v_exp_f32 v41, v41
    v_cvt_pk_bf16_f32 v30, v38, v39
    v_cvt_pk_bf16_f32 v31, v40, v41
    v_mfma_f32_32x32x16_bf16 v[120:135], v[26:29], v[34:37], v[120:135]
    s_mov_b64 exec, s[20:21]
    ds_read_b128 v[26:29], v73 offset:6400
    s_mov_b64 exec, -1
    v_exp_f32 v42, v42
    v_exp_f32 v43, v43
    v_exp_f32 v44, v44
    v_exp_f32 v45, v45
    v_cvt_pk_bf16_f32 v32, v42, v43
    v_cvt_pk_bf16_f32 v33, v44, v45
    v_mfma_f32_32x32x8_bf16 v[54:69], v[20:21], v[14:15], v[54:69]
    ds_read_b32 v20, v71 offset:8704
    v_exp_f32 v46, v46
    v_exp_f32 v47, v47
    v_exp_f32 v48, v48
    v_exp_f32 v49, v49
    v_cvt_pk_bf16_f32 v34, v46, v47
    v_cvt_pk_bf16_f32 v35, v48, v49
    s_waitcnt lgkmcnt(2)
    v_mfma_f32_32x32x16_bf16 v[104:119], v[22:25], v[30:33], v[104:119]
    v_exp_f32 v50, v50
    v_exp_f32 v51, v51
    v_exp_f32 v52, v52
    v_exp_f32 v53, v53
    v_cvt_pk_bf16_f32 v36, v50, v51
    v_cvt_pk_bf16_f32 v37, v52, v53
    v_mfma_f32_32x32x16_bf16 v[38:53], v[16:19], v[4:7], 0
    v_exp_f32 v54, v54
    v_exp_f32 v55, v55
    v_exp_f32 v56, v56
    v_exp_f32 v57, v57
    v_cvt_pk_bf16_f32 v30, v54, v55
    v_cvt_pk_bf16_f32 v31, v56, v57
    s_waitcnt lgkmcnt(0)
    v_mfma_f32_32x32x16_bf16 v[104:119], v[26:29], v[34:37], v[104:119]
    v_exp_f32 v58, v58
    v_exp_f32 v59, v59
    v_exp_f32 v60, v60
    v_exp_f32 v61, v61
    v_cvt_pk_bf16_f32 v32, v58, v59
    v_cvt_pk_bf16_f32 v33, v60, v61
    v_mfma_f32_32x32x8_bf16 v[38:53], v[20:21], v[12:13], v[38:53]
    v_exp_f32 v62, v62
    v_exp_f32 v63, v63
    v_exp_f32 v64, v64
    v_exp_f32 v65, v65
    v_cvt_pk_bf16_f32 v34, v62, v63
    v_cvt_pk_bf16_f32 v35, v64, v65
    v_mfma_f32_32x32x16_bf16 v[120:135], v[22:25], v[30:33], v[120:135]
    s_mov_b64 exec, s[20:21]
    ds_read_b128 v[22:25], v72 offset:8960
    s_mov_b64 exec, -1
    v_exp_f32 v66, v66
    v_exp_f32 v67, v67
    v_exp_f32 v68, v68
    v_exp_f32 v69, v69
    v_cvt_pk_bf16_f32 v36, v66, v67
    v_cvt_pk_bf16_f32 v37, v68, v69
    v_mfma_f32_32x32x16_bf16 v[54:69], v[16:19], v[8:11], 0
    ds_read_b128 v[16:19], v70 offset:10240
    v_exp_f32 v38, v38
    v_exp_f32 v39, v39
    v_exp_f32 v40, v40
    v_exp_f32 v41, v41
    v_cvt_pk_bf16_f32 v30, v38, v39
    v_cvt_pk_bf16_f32 v31, v40, v41
    v_mfma_f32_32x32x16_bf16 v[120:135], v[26:29], v[34:37], v[120:135]
    s_mov_b64 exec, s[20:21]
    ds_read_b128 v[26:29], v73 offset:8960
    s_mov_b64 exec, -1
    v_exp_f32 v42, v42
    v_exp_f32 v43, v43
    v_exp_f32 v44, v44
    v_exp_f32 v45, v45
    v_cvt_pk_bf16_f32 v32, v42, v43
    v_cvt_pk_bf16_f32 v33, v44, v45
    v_mfma_f32_32x32x8_bf16 v[54:69], v[20:21], v[14:15], v[54:69]
    ds_read_b32 v20, v71 offset:11264
    v_exp_f32 v46, v46
    v_exp_f32 v47, v47
    v_exp_f32 v48, v48
    v_exp_f32 v49, v49
    v_cvt_pk_bf16_f32 v34, v46, v47
    v_cvt_pk_bf16_f32 v35, v48, v49
    s_waitcnt lgkmcnt(2)
    v_mfma_f32_32x32x16_bf16 v[104:119], v[22:25], v[30:33], v[104:119]
    v_exp_f32 v50, v50
    v_exp_f32 v51, v51
    v_exp_f32 v52, v52
    v_exp_f32 v53, v53
    v_cvt_pk_bf16_f32 v36, v50, v51
    v_cvt_pk_bf16_f32 v37, v52, v53
    v_mfma_f32_32x32x16_bf16 v[38:53], v[16:19], v[4:7], 0
    v_exp_f32 v54, v54
    v_exp_f32 v55, v55
    v_exp_f32 v56, v56
    v_exp_f32 v57, v57
    v_cvt_pk_bf16_f32 v30, v54, v55
    v_cvt_pk_bf16_f32 v31, v56, v57
    s_waitcnt lgkmcnt(0)
    v_mfma_f32_32x32x16_bf16 v[104:119], v[26:29], v[34:37], v[104:119]
    v_exp_f32 v58, v58
    v_exp_f32 v59, v59
    v_exp_f32 v60, v60
    v_exp_f32 v61, v61
    v_cvt_pk_bf16_f32 v32, v58, v59
    v_cvt_pk_bf16_f32 v33, v60, v61
    v_mfma_f32_32x32x8_bf16 v[38:53], v[20:21], v[12:13], v[38:53]
    v_exp_f32 v62, v62
    v_exp_f32 v63, v63
    v_exp_f32 v64, v64
    v_exp_f32 v65, v65
    v_cvt_pk_bf16_f32 v34, v62, v63
    v_cvt_pk_bf16_f32 v35, v64, v65
    v_mfma_f32_32x32x16_bf16 v[120:135], v[22:25], v[30:33], v[120:135]
    s_mov_b64 exec, s[20:21]
    ds_read_b128 v[22:25], v72 offset:11520
    s_mov_b64 exec, -1
    v_exp_f32 v66, v66
    v_exp_f32 v67, v67
    v_exp_f32 v68, v68
    v_exp_f32 v69, v69
    v_add_u32 v70, 10240, v70
    v_add_u32 v71, 10240, v71
    v_add_u32 v72, 10240, v72
    v_add_u32 v73, 10240, v73
    v_cvt_pk_bf16_f32 v36, v66, v67
    v_cvt_pk_bf16_f32 v37, v68, v69
    s_add_u32 s24, s24, 1
    s_bitcmp1_b32 0x1f2, s24
    s_cbranch_scc0 L2_loop
    s_cmp_lg_u32 s24, 1
    s_cbranch_scc1 L2_sp1
    s_barrier
    s_branch L2_loop
L2_sp1:
    s_cmp_lg_u32 s24, 4
    s_cbranch_scc1 L2_sp4
    s_lshl_b32 s28, s18, 2
    s_add_u32 s28, s28, 10224
    v_mov_b32 v164, s28
    v_mov_b32 v165, 0xffff7fff
    ds_write_b32 v164, v165
    s_waitcnt lgkmcnt(0)
    s_branch L2_loop
L2_sp4:
    s_cmp_lg_u32 s24, 5
    s_cbranch_scc1 L2_sp5
    s_setprio 2
    s_branch L2_loop
L2_sp5:
    s_cmp_lg_u32 s24, 6
    s_cbranch_scc1 L2_sp6
    s_lshl_b32 s28, s18, 2
    s_add_u32 s28, s28, 10256
    v_mov_b32 v164, s28
    v_mov_b32 v165, 0xffff7fff
    ds_write_b32 v164, v165
    s_waitcnt lgkmcnt(0)
    s_branch L2_loop
L2_sp6:
    s_cmp_lg_u32 s24, 7
    s_cbranch_scc1 L2_sp7
    s_setprio 1
    s_branch L2_loop
L2_sp7:
    s_waitcnt lgkmcnt(0)
    v_mfma_f32_32x32x16_bf16 v[120:135], v[26:29], v[34:37], v[120:135]
L2_epi:
    s_nop 15
    v_mov_b32 v166, 0x30800000
    v_mov_b32 v167, 0x4e800000
    s_mov_b64 vcc, 0
    v_cndmask_b32 v116, v116, v112, s[22:23]
    v_mov_b32 v117, v162
    v_cmp_nge_f32 s[32:33], v116, v166
    v_cmp_nle_f32 s[34:35], v116, v167
    s_or_b64 vcc, vcc, s[32:33]
    s_or_b64 vcc, vcc, s[34:35]
    v_cndmask_b32 v132, v132, v128, s[22:23]
    v_mov_b32 v133, v163
    v_cmp_nge_f32 s[32:33], v132, v166
    v_cmp_nle_f32 s[34:35], v132, v167
    s_or_b64 vcc, vcc, s[32:33]
    s_or_b64 vcc, vcc, s[34:35]
    s_cselect_b32 s28, 1, 0
    s_andn2_b32 s28, s28, s25
    s_cbranch_scc1 L2_fallback
    s_setprio 3
    s_barrier
    ds_write_b64 v161, v[132:133] offset:3072
    ds_write_b128 v159, v[120:123] offset:0
    ds_write_b128 v159, v[124:127] offset:1024
    ds_write_b128 v159, v[128:131] offset:2048
    s_waitcnt lgkmcnt(0)
    s_barrier
    ds_read_b64 v[148:149], v160 offset:3072
    ds_read_b128 v[136:139], v158 offset:0
    ds_read_b128 v[140:143], v158 offset:1024
    ds_read_b128 v[144:147], v158 offset:2048
    s_waitcnt lgkmcnt(3)
    v_max_f32 v165, v117, v149
    v_sub_f32 v166, v117, v165
    v_sub_f32 v167, v149, v165
    v_exp_f32 v166, v166
    v_exp_f32 v167, v167
    v_mul_f32 v120, v116, v166
    v_fmac_f32 v120, v148, v167
    v_rcp_f32 v121, v120
    s_nop 0
    v_mul_f32 v166, v166, v121
    v_mul_f32 v167, v167, v121
    v_mul_f32 v104, v104, v166
    v_mul_f32 v105, v105, v166
    v_mul_f32 v106, v106, v166
    v_mul_f32 v107, v107, v166
    v_mul_f32 v108, v108, v166
    v_mul_f32 v109, v109, v166
    v_mul_f32 v110, v110, v166
    v_mul_f32 v111, v111, v166
    v_mul_f32 v112, v112, v166
    v_mul_f32 v113, v113, v166
    v_mul_f32 v114, v114, v166
    v_mul_f32 v115, v115, v166
    s_waitcnt lgkmcnt(0)
    v_fmac_f32 v104, v136, v167
    v_fmac_f32 v105, v137, v167
    v_fmac_f32 v106, v138, v167
    v_fmac_f32 v107, v139, v167
    v_fmac_f32 v108, v140, v167
    v_fmac_f32 v109, v141, v167
    v_fmac_f32 v110, v142, v167
    v_fmac_f32 v111, v143, v167
    v_fmac_f32 v112, v144, v167
    v_fmac_f32 v113, v145, v167
    v_fmac_f32 v114, v146, v167
    v_fmac_f32 v115, v147, v167
    v_cvt_pk_bf16_f32 v120, v104, v105
    v_cvt_pk_bf16_f32 v121, v106, v107
    v_cvt_pk_bf16_f32 v122, v108, v109
    v_cvt_pk_bf16_f32 v123, v110, v111
    v_cvt_pk_bf16_f32 v124, v112, v113
    v_cvt_pk_bf16_f32 v125, v114, v115
    v_min_u32 v120, -2, v120
    v_min_u32 v121, -2, v121
    v_min_u32 v122, -2, v122
    v_min_u32 v123, -2, v123
    v_min_u32 v124, -2, v124
    v_min_u32 v125, -2, v125
    buffer_store_dwordx4 v[120:123], v156, s[12:15], s61 offen sc1
    s_mov_b32 exec_hi, 0
    buffer_store_dwordx2 v[124:125], v157, s[12:15], s62 offen sc1
    s_mov_b64 exec, -1
    s_waitcnt vmcnt(0)
    s_barrier
    buffer_load_dwordx4 v[24:27], v1, s[12:15], s56 offen offset:0 sc1
    buffer_load_dwordx4 v[28:31], v1, s[12:15], s56 offen offset:1024 sc1
    v_add_u32 v2, s64, v1
    ds_read_b128 v[64:67], v2 offset:0
    ds_read_b128 v[68:71], v2 offset:1024
    ds_read_b128 v[72:75], v2 offset:2048
    ds_read_b128 v[76:79], v2 offset:3072
    ds_read_b128 v[80:83], v2 offset:4096
    ds_read_b128 v[84:87], v2 offset:5120
    ds_read_b128 v[88:91], v2 offset:6144
    ds_read_b128 v[92:95], v2 offset:7168
    ds_read_b128 v[96:99], v2 offset:8192
    ds_read_b128 v[100:103], v2 offset:9216
    v_mov_b32 v4, 0
    v_mov_b32 v5, 0
    v_mov_b32 v6, 0
    v_mov_b32 v7, 0
    v_mov_b32 v8, 0
    v_mov_b32 v9, 0
    v_mov_b32 v10, 0
    v_mov_b32 v11, 0
    v_mov_b32 v12, 0
    v_mov_b32 v13, 0
    v_mov_b32 v14, 0
    v_mov_b32 v15, 0
    v_mov_b32 v16, 0
    v_mov_b32 v17, 0
    v_mov_b32 v18, 0
    v_mov_b32 v19, 0
    v_mov_b32 v20, 0
    v_mov_b32 v21, 0
    v_mov_b32 v22, 0
    v_mov_b32 v23, 0
    s_mov_b32 s30, 63
    s_mov_b32 s29, 262144
    buffer_load_dwordx2 v[56:57], v3, s[12:15], s60 offen offset:0 sc1
    buffer_load_dwordx2 v[58:59], v3, s[12:15], s60 offen offset:256 sc1
    s_waitcnt lgkmcnt(0)
    v_add_u32 v2, s68, v1
    ds_read_b128 v[104:107], v2 offset:0
    ds_read_b128 v[108:111], v2 offset:1024
    ds_read_b128 v[112:115], v2 offset:2048
    ds_read_b128 v[116:119], v2 offset:3072
    ds_read_b128 v[120:123], v2 offset:4096
    s_waitcnt vmcnt(2)
    v_max3_u32 v164, v24, v25, v26
    v_max3_u32 v165, v27, v28, v29
    v_max3_u32 v164, v164, v30, v31
    v_max_u32 v164, v164, v165
    v_cmp_eq_u32 vcc, -1, v164
    s_cbranch_vccnz L2_f0
    s_bitset0_b32 s30, 0
    v_mfma_f32_16x16x32_bf16 v[4:7], v[64:67], v[24:27], v[4:7]
    v_mfma_f32_16x16x32_bf16 v[8:11], v[68:71], v[24:27], v[8:11]
    v_mfma_f32_16x16x32_bf16 v[12:15], v[72:75], v[24:27], v[12:15]
    v_mfma_f32_16x16x32_bf16 v[16:19], v[76:79], v[24:27], v[16:19]
    v_mfma_f32_16x16x32_bf16 v[20:23], v[80:83], v[24:27], v[20:23]
    v_mfma_f32_16x16x32_bf16 v[4:7], v[84:87], v[28:31], v[4:7]
    v_mfma_f32_16x16x32_bf16 v[8:11], v[88:91], v[28:31], v[8:11]
    v_mfma_f32_16x16x32_bf16 v[12:15], v[92:95], v[28:31], v[12:15]
    v_mfma_f32_16x16x32_bf16 v[16:19], v[96:99], v[28:31], v[16:19]
    v_mfma_f32_16x16x32_bf16 v[20:23], v[100:103], v[28:31], v[20:23]
L2_f0:
    buffer_load_dwordx4 v[32:35], v1, s[12:15], s57 offen offset:0 sc1
    buffer_load_dwordx4 v[36:39], v1, s[12:15], s57 offen offset:1024 sc1
    s_waitcnt lgkmcnt(0)
    v_add_u32 v2, s65, v1
    ds_read_b128 v[64:67], v2 offset:0
    ds_read_b128 v[68:71], v2 offset:1024
    ds_read_b128 v[72:75], v2 offset:2048
    ds_read_b128 v[76:79], v2 offset:3072
    ds_read_b128 v[80:83], v2 offset:4096
    ds_read_b128 v[84:87], v2 offset:5120
    ds_read_b128 v[88:91], v2 offset:6144
    ds_read_b128 v[92:95], v2 offset:7168
    ds_read_b128 v[96:99], v2 offset:8192
    ds_read_b128 v[100:103], v2 offset:9216
    s_waitcnt vmcnt(2)
    v_max3_u32 v164, v56, v57, v58
    v_max_u32 v164, v164, v59
    v_cmp_eq_u32 vcc, -1, v164
    s_cbranch_vccnz L2_f4
    s_bitset0_b32 s30, 4
    v_mfma_f32_16x16x32_bf16 v[4:7], v[104:107], v[56:59], v[4:7]
    v_mfma_f32_16x16x32_bf16 v[8:11], v[108:111], v[56:59], v[8:11]
    v_mfma_f32_16x16x32_bf16 v[12:15], v[112:115], v[56:59], v[12:15]
    v_mfma_f32_16x16x32_bf16 v[16:19], v[116:119], v[56:59], v[16:19]
    v_mfma_f32_16x16x32_bf16 v[20:23], v[120:123], v[56:59], v[20:23]
L2_f4:
    buffer_load_dwordx2 v[60:61], v3, s[12:15], s60 offen offset:2048 sc1
    buffer_load_dwordx2 v[62:63], v3, s[12:15], s60 offen offset:2304 sc1
    s_waitcnt lgkmcnt(0)
    v_add_u32 v2, s69, v1
    ds_read_b128 v[104:107], v2 offset:0
    ds_read_b128 v[108:111], v2 offset:1024
    ds_read_b128 v[112:115], v2 offset:2048
    ds_read_b128 v[116:119], v2 offset:3072
    ds_read_b128 v[120:123], v2 offset:4096
    s_waitcnt vmcnt(2)
    v_max3_u32 v164, v32, v33, v34
    v_max3_u32 v165, v35, v36, v37
    v_max3_u32 v164, v164, v38, v39
    v_max_u32 v164, v164, v165
    v_cmp_eq_u32 vcc, -1, v164
    s_cbranch_vccnz L2_f1
    s_bitset0_b32 s30, 1
    v_mfma_f32_16x16x32_bf16 v[4:7], v[64:67], v[32:35], v[4:7]
    v_mfma_f32_16x16x32_bf16 v[8:11], v[68:71], v[32:35], v[8:11]
    v_mfma_f32_16x16x32_bf16 v[12:15], v[72:75], v[32:35], v[12:15]
    v_mfma_f32_16x16x32_bf16 v[16:19], v[76:79], v[32:35], v[16:19]
    v_mfma_f32_16x16x32_bf16 v[20:23], v[80:83], v[32:35], v[20:23]
    v_mfma_f32_16x16x32_bf16 v[4:7], v[84:87], v[36:39], v[4:7]
    v_mfma_f32_16x16x32_bf16 v[8:11], v[88:91], v[36:39], v[8:11]
    v_mfma_f32_16x16x32_bf16 v[12:15], v[92:95], v[36:39], v[12:15]
    v_mfma_f32_16x16x32_bf16 v[16:19], v[96:99], v[36:39], v[16:19]
    v_mfma_f32_16x16x32_bf16 v[20:23], v[100:103], v[36:39], v[20:23]
L2_f1:
    buffer_load_dwordx4 v[40:43], v1, s[12:15], s58 offen offset:0 sc1
    buffer_load_dwordx4 v[44:47], v1, s[12:15], s58 offen offset:1024 sc1
    s_waitcnt lgkmcnt(0)
    v_add_u32 v2, s66, v1
    ds_read_b128 v[64:67], v2 offset:0
    ds_read_b128 v[68:71], v2 offset:1024
    ds_read_b128 v[72:75], v2 offset:2048
    ds_read_b128 v[76:79], v2 offset:3072
    ds_read_b128 v[80:83], v2 offset:4096
    ds_read_b128 v[84:87], v2 offset:5120
    ds_read_b128 v[88:91], v2 offset:6144
    ds_read_b128 v[92:95], v2 offset:7168
    ds_read_b128 v[96:99], v2 offset:8192
    ds_read_b128 v[100:103], v2 offset:9216
    s_waitcnt vmcnt(2)
    v_max3_u32 v164, v60, v61, v62
    v_max_u32 v164, v164, v63
    v_cmp_eq_u32 vcc, -1, v164
    s_cbranch_vccnz L2_f5
    s_bitset0_b32 s30, 5
    v_mfma_f32_16x16x32_bf16 v[4:7], v[104:107], v[60:63], v[4:7]
    v_mfma_f32_16x16x32_bf16 v[8:11], v[108:111], v[60:63], v[8:11]
    v_mfma_f32_16x16x32_bf16 v[12:15], v[112:115], v[60:63], v[12:15]
    v_mfma_f32_16x16x32_bf16 v[16:19], v[116:119], v[60:63], v[16:19]
    v_mfma_f32_16x16x32_bf16 v[20:23], v[120:123], v[60:63], v[20:23]
L2_f5:
    buffer_load_dwordx4 v[48:51], v1, s[12:15], s59 offen offset:0 sc1
    buffer_load_dwordx4 v[52:55], v1, s[12:15], s59 offen offset:1024 sc1
    s_waitcnt lgkmcnt(0)
    v_add_u32 v2, s67, v1
    ds_read_b128 v[104:107], v2 offset:0
    ds_read_b128 v[108:111], v2 offset:1024
    ds_read_b128 v[112:115], v2 offset:2048
    ds_read_b128 v[116:119], v2 offset:3072
    ds_read_b128 v[120:123], v2 offset:4096
    ds_read_b128 v[124:127], v2 offset:5120
    ds_read_b128 v[128:131], v2 offset:6144
    ds_read_b128 v[132:135], v2 offset:7168
    ds_read_b128 v[136:139], v2 offset:8192
    ds_read_b128 v[140:143], v2 offset:9216
    s_waitcnt vmcnt(2)
    v_max3_u32 v164, v40, v41, v42
    v_max3_u32 v165, v43, v44, v45
    v_max3_u32 v164, v164, v46, v47
    v_max_u32 v164, v164, v165
    v_cmp_eq_u32 vcc, -1, v164
    s_cbranch_vccnz L2_f2
    s_bitset0_b32 s30, 2
    v_mfma_f32_16x16x32_bf16 v[4:7], v[64:67], v[40:43], v[4:7]
    v_mfma_f32_16x16x32_bf16 v[8:11], v[68:71], v[40:43], v[8:11]
    v_mfma_f32_16x16x32_bf16 v[12:15], v[72:75], v[40:43], v[12:15]
    v_mfma_f32_16x16x32_bf16 v[16:19], v[76:79], v[40:43], v[16:19]
    v_mfma_f32_16x16x32_bf16 v[20:23], v[80:83], v[40:43], v[20:23]
    v_mfma_f32_16x16x32_bf16 v[4:7], v[84:87], v[44:47], v[4:7]
    v_mfma_f32_16x16x32_bf16 v[8:11], v[88:91], v[44:47], v[8:11]
    v_mfma_f32_16x16x32_bf16 v[12:15], v[92:95], v[44:47], v[12:15]
    v_mfma_f32_16x16x32_bf16 v[16:19], v[96:99], v[44:47], v[16:19]
    v_mfma_f32_16x16x32_bf16 v[20:23], v[100:103], v[44:47], v[20:23]
L2_f2:
    s_waitcnt lgkmcnt(0)
    s_waitcnt vmcnt(0)
    v_max3_u32 v164, v48, v49, v50
    v_max3_u32 v165, v51, v52, v53
    v_max3_u32 v164, v164, v54, v55
    v_max_u32 v164, v164, v165
    v_cmp_eq_u32 vcc, -1, v164
    s_cbranch_vccnz L2_f3
    s_bitset0_b32 s30, 3
    v_mfma_f32_16x16x32_bf16 v[4:7], v[104:107], v[48:51], v[4:7]
    v_mfma_f32_16x16x32_bf16 v[8:11], v[108:111], v[48:51], v[8:11]
    v_mfma_f32_16x16x32_bf16 v[12:15], v[112:115], v[48:51], v[12:15]
    v_mfma_f32_16x16x32_bf16 v[16:19], v[116:119], v[48:51], v[16:19]
    v_mfma_f32_16x16x32_bf16 v[20:23], v[120:123], v[48:51], v[20:23]
    v_mfma_f32_16x16x32_bf16 v[4:7], v[124:127], v[52:55], v[4:7]
    v_mfma_f32_16x16x32_bf16 v[8:11], v[128:131], v[52:55], v[8:11]
    v_mfma_f32_16x16x32_bf16 v[12:15], v[132:135], v[52:55], v[12:15]
    v_mfma_f32_16x16x32_bf16 v[16:19], v[136:139], v[52:55], v[16:19]
    v_mfma_f32_16x16x32_bf16 v[20:23], v[140:143], v[52:55], v[20:23]
L2_f3:
    s_branch L2_pchk
L2_pass:
    s_bitcmp1_b32 s30, 0
    s_cbranch_scc0 L2_pn0
    v_add_u32 v2, s64, v1
    ds_read_b128 v[64:67], v2 offset:0
    ds_read_b128 v[68:71], v2 offset:1024
    ds_read_b128 v[72:75], v2 offset:2048
    ds_read_b128 v[76:79], v2 offset:3072
    ds_read_b128 v[80:83], v2 offset:4096
    ds_read_b128 v[84:87], v2 offset:5120
    ds_read_b128 v[88:91], v2 offset:6144
    ds_read_b128 v[92:95], v2 offset:7168
    ds_read_b128 v[96:99], v2 offset:8192
    ds_read_b128 v[100:103], v2 offset:9216
    v_max3_u32 v164, v24, v25, v26
    v_max3_u32 v165, v27, v28, v29
    v_max3_u32 v164, v164, v30, v31
    v_max_u32 v164, v164, v165
    v_cmp_eq_u32 vcc, -1, v164
    s_cbranch_vccnz L2_ps0
    s_bitset0_b32 s30, 0
    s_waitcnt lgkmcnt(8)
    v_mfma_f32_16x16x32_bf16 v[4:7], v[64:67], v[24:27], v[4:7]
    v_mfma_f32_16x16x32_bf16 v[8:11], v[68:71], v[24:27], v[8:11]
    s_waitcnt lgkmcnt(6)
    v_mfma_f32_16x16x32_bf16 v[12:15], v[72:75], v[24:27], v[12:15]
    v_mfma_f32_16x16x32_bf16 v[16:19], v[76:79], v[24:27], v[16:19]
    s_waitcnt lgkmcnt(4)
    v_mfma_f32_16x16x32_bf16 v[20:23], v[80:83], v[24:27], v[20:23]
    v_mfma_f32_16x16x32_bf16 v[4:7], v[84:87], v[28:31], v[4:7]
    s_waitcnt lgkmcnt(2)
    v_mfma_f32_16x16x32_bf16 v[8:11], v[88:91], v[28:31], v[8:11]
    v_mfma_f32_16x16x32_bf16 v[12:15], v[92:95], v[28:31], v[12:15]
    s_waitcnt lgkmcnt(0)
    v_mfma_f32_16x16x32_bf16 v[16:19], v[96:99], v[28:31], v[16:19]
    s_waitcnt lgkmcnt(0)
    v_mfma_f32_16x16x32_bf16 v[20:23], v[100:103], v[28:31], v[20:23]
L2_ps0:
    s_waitcnt lgkmcnt(0)
L2_pn0:
    s_bitcmp1_b32 s30, 4
    s_cbranch_scc0 L2_pn4
    v_add_u32 v2, s68, v1
    ds_read_b128 v[64:67], v2 offset:0
    ds_read_b128 v[68:71], v2 offset:1024
    ds_read_b128 v[72:75], v2 offset:2048
    ds_read_b128 v[76:79], v2 offset:3072
    ds_read_b128 v[80:83], v2 offset:4096
    v_max3_u32 v164, v56, v57, v58
    v_max_u32 v164, v164, v59
    v_cmp_eq_u32 vcc, -1, v164
    s_cbranch_vccnz L2_ps4
    s_bitset0_b32 s30, 4
    s_waitcnt lgkmcnt(3)
    v_mfma_f32_16x16x32_bf16 v[4:7], v[64:67], v[56:59], v[4:7]
    v_mfma_f32_16x16x32_bf16 v[8:11], v[68:71], v[56:59], v[8:11]
    s_waitcnt lgkmcnt(1)
    v_mfma_f32_16x16x32_bf16 v[12:15], v[72:75], v[56:59], v[12:15]
    v_mfma_f32_16x16x32_bf16 v[16:19], v[76:79], v[56:59], v[16:19]
    s_waitcnt lgkmcnt(0)
    v_mfma_f32_16x16x32_bf16 v[20:23], v[80:83], v[56:59], v[20:23]
L2_ps4:
    s_waitcnt lgkmcnt(0)
L2_pn4:
    s_bitcmp1_b32 s30, 1
    s_cbranch_scc0 L2_pn1
    v_add_u32 v2, s65, v1
    ds_read_b128 v[64:67], v2 offset:0
    ds_read_b128 v[68:71], v2 offset:1024
    ds_read_b128 v[72:75], v2 offset:2048
    ds_read_b128 v[76:79], v2 offset:3072
    ds_read_b128 v[80:83], v2 offset:4096
    ds_read_b128 v[84:87], v2 offset:5120
    ds_read_b128 v[88:91], v2 offset:6144
    ds_read_b128 v[92:95], v2 offset:7168
    ds_read_b128 v[96:99], v2 offset:8192
    ds_read_b128 v[100:103], v2 offset:9216
    v_max3_u32 v164, v32, v33, v34
    v_max3_u32 v165, v35, v36, v37
    v_max3_u32 v164, v164, v38, v39
    v_max_u32 v164, v164, v165
    v_cmp_eq_u32 vcc, -1, v164
    s_cbranch_vccnz L2_ps1
    s_bitset0_b32 s30, 1
    s_waitcnt lgkmcnt(8)
    v_mfma_f32_16x16x32_bf16 v[4:7], v[64:67], v[32:35], v[4:7]
    v_mfma_f32_16x16x32_bf16 v[8:11], v[68:71], v[32:35], v[8:11]
    s_waitcnt lgkmcnt(6)
    v_mfma_f32_16x16x32_bf16 v[12:15], v[72:75], v[32:35], v[12:15]
    v_mfma_f32_16x16x32_bf16 v[16:19], v[76:79], v[32:35], v[16:19]
    s_waitcnt lgkmcnt(4)
    v_mfma_f32_16x16x32_bf16 v[20:23], v[80:83], v[32:35], v[20:23]
    v_mfma_f32_16x16x32_bf16 v[4:7], v[84:87], v[36:39], v[4:7]
    s_waitcnt lgkmcnt(2)
    v_mfma_f32_16x16x32_bf16 v[8:11], v[88:91], v[36:39], v[8:11]
    v_mfma_f32_16x16x32_bf16 v[12:15], v[92:95], v[36:39], v[12:15]
    s_waitcnt lgkmcnt(0)
    v_mfma_f32_16x16x32_bf16 v[16:19], v[96:99], v[36:39], v[16:19]
    s_waitcnt lgkmcnt(0)
    v_mfma_f32_16x16x32_bf16 v[20:23], v[100:103], v[36:39], v[20:23]
L2_ps1:
    s_waitcnt lgkmcnt(0)
L2_pn1:
    s_bitcmp1_b32 s30, 5
    s_cbranch_scc0 L2_pn5
    v_add_u32 v2, s69, v1
    ds_read_b128 v[64:67], v2 offset:0
    ds_read_b128 v[68:71], v2 offset:1024
    ds_read_b128 v[72:75], v2 offset:2048
    ds_read_b128 v[76:79], v2 offset:3072
    ds_read_b128 v[80:83], v2 offset:4096
    v_max3_u32 v164, v60, v61, v62
    v_max_u32 v164, v164, v63
    v_cmp_eq_u32 vcc, -1, v164
    s_cbranch_vccnz L2_ps5
    s_bitset0_b32 s30, 5
    s_waitcnt lgkmcnt(3)
    v_mfma_f32_16x16x32_bf16 v[4:7], v[64:67], v[60:63], v[4:7]
    v_mfma_f32_16x16x32_bf16 v[8:11], v[68:71], v[60:63], v[8:11]
    s_waitcnt lgkmcnt(1)
    v_mfma_f32_16x16x32_bf16 v[12:15], v[72:75], v[60:63], v[12:15]
    v_mfma_f32_16x16x32_bf16 v[16:19], v[76:79], v[60:63], v[16:19]
    s_waitcnt lgkmcnt(0)
    v_mfma_f32_16x16x32_bf16 v[20:23], v[80:83], v[60:63], v[20:23]
L2_ps5:
    s_waitcnt lgkmcnt(0)
L2_pn5:
    s_bitcmp1_b32 s30, 2
    s_cbranch_scc0 L2_pn2
    v_add_u32 v2, s66, v1
    ds_read_b128 v[64:67], v2 offset:0
    ds_read_b128 v[68:71], v2 offset:1024
    ds_read_b128 v[72:75], v2 offset:2048
    ds_read_b128 v[76:79], v2 offset:3072
    ds_read_b128 v[80:83], v2 offset:4096
    ds_read_b128 v[84:87], v2 offset:5120
    ds_read_b128 v[88:91], v2 offset:6144
    ds_read_b128 v[92:95], v2 offset:7168
    ds_read_b128 v[96:99], v2 offset:8192
    ds_read_b128 v[100:103], v2 offset:9216
    v_max3_u32 v164, v40, v41, v42
    v_max3_u32 v165, v43, v44, v45
    v_max3_u32 v164, v164, v46, v47
    v_max_u32 v164, v164, v165
    v_cmp_eq_u32 vcc, -1, v164
    s_cbranch_vccnz L2_ps2
    s_bitset0_b32 s30, 2
    s_waitcnt lgkmcnt(8)
    v_mfma_f32_16x16x32_bf16 v[4:7], v[64:67], v[40:43], v[4:7]
    v_mfma_f32_16x16x32_bf16 v[8:11], v[68:71], v[40:43], v[8:11]
    s_waitcnt lgkmcnt(6)
    v_mfma_f32_16x16x32_bf16 v[12:15], v[72:75], v[40:43], v[12:15]
    v_mfma_f32_16x16x32_bf16 v[16:19], v[76:79], v[40:43], v[16:19]
    s_waitcnt lgkmcnt(4)
    v_mfma_f32_16x16x32_bf16 v[20:23], v[80:83], v[40:43], v[20:23]
    v_mfma_f32_16x16x32_bf16 v[4:7], v[84:87], v[44:47], v[4:7]
    s_waitcnt lgkmcnt(2)
    v_mfma_f32_16x16x32_bf16 v[8:11], v[88:91], v[44:47], v[8:11]
    v_mfma_f32_16x16x32_bf16 v[12:15], v[92:95], v[44:47], v[12:15]
    s_waitcnt lgkmcnt(0)
    v_mfma_f32_16x16x32_bf16 v[16:19], v[96:99], v[44:47], v[16:19]
    s_waitcnt lgkmcnt(0)
    v_mfma_f32_16x16x32_bf16 v[20:23], v[100:103], v[44:47], v[20:23]
L2_ps2:
    s_waitcnt lgkmcnt(0)
L2_pn2:
    s_bitcmp1_b32 s30, 3
    s_cbranch_scc0 L2_pn3
    v_add_u32 v2, s67, v1
    ds_read_b128 v[64:67], v2 offset:0
    ds_read_b128 v[68:71], v2 offset:1024
    ds_read_b128 v[72:75], v2 offset:2048
    ds_read_b128 v[76:79], v2 offset:3072
    ds_read_b128 v[80:83], v2 offset:4096
    ds_read_b128 v[84:87], v2 offset:5120
    ds_read_b128 v[88:91], v2 offset:6144
    ds_read_b128 v[92:95], v2 offset:7168
    ds_read_b128 v[96:99], v2 offset:8192
    ds_read_b128 v[100:103], v2 offset:9216
    v_max3_u32 v164, v48, v49, v50
    v_max3_u32 v165, v51, v52, v53
    v_max3_u32 v164, v164, v54, v55
    v_max_u32 v164, v164, v165
    v_cmp_eq_u32 vcc, -1, v164
    s_cbranch_vccnz L2_ps3
    s_bitset0_b32 s30, 3
    s_waitcnt lgkmcnt(8)
    v_mfma_f32_16x16x32_bf16 v[4:7], v[64:67], v[48:51], v[4:7]
    v_mfma_f32_16x16x32_bf16 v[8:11], v[68:71], v[48:51], v[8:11]
    s_waitcnt lgkmcnt(6)
    v_mfma_f32_16x16x32_bf16 v[12:15], v[72:75], v[48:51], v[12:15]
    v_mfma_f32_16x16x32_bf16 v[16:19], v[76:79], v[48:51], v[16:19]
    s_waitcnt lgkmcnt(4)
    v_mfma_f32_16x16x32_bf16 v[20:23], v[80:83], v[48:51], v[20:23]
    v_mfma_f32_16x16x32_bf16 v[4:7], v[84:87], v[52:55], v[4:7]
    s_waitcnt lgkmcnt(2)
    v_mfma_f32_16x16x32_bf16 v[8:11], v[88:91], v[52:55], v[8:11]
    v_mfma_f32_16x16x32_bf16 v[12:15], v[92:95], v[52:55], v[12:15]
    s_waitcnt lgkmcnt(0)
    v_mfma_f32_16x16x32_bf16 v[16:19], v[96:99], v[52:55], v[16:19]
    s_waitcnt lgkmcnt(0)
    v_mfma_f32_16x16x32_bf16 v[20:23], v[100:103], v[52:55], v[20:23]
L2_ps3:
    s_waitcnt lgkmcnt(0)
L2_pn3:
L2_pchk:
    s_bitcmp1_b32 s30, 0
    s_cbranch_scc0 L2_pl0
    buffer_load_dwordx4 v[24:27], v1, s[12:15], s56 offen offset:0 sc1
    buffer_load_dwordx4 v[28:31], v1, s[12:15], s56 offen offset:1024 sc1
L2_pl0:
    s_bitcmp1_b32 s30, 4
    s_cbranch_scc0 L2_pl4
    buffer_load_dwordx2 v[56:57], v3, s[12:15], s60 offen offset:0 sc1
    buffer_load_dwordx2 v[58:59], v3, s[12:15], s60 offen offset:256 sc1
L2_pl4:
    s_bitcmp1_b32 s30, 1
    s_cbranch_scc0 L2_pl1
    buffer_load_dwordx4 v[32:35], v1, s[12:15], s57 offen offset:0 sc1
    buffer_load_dwordx4 v[36:39], v1, s[12:15], s57 offen offset:1024 sc1
L2_pl1:
    s_bitcmp1_b32 s30, 5
    s_cbranch_scc0 L2_pl5
    buffer_load_dwordx2 v[60:61], v3, s[12:15], s60 offen offset:2048 sc1
    buffer_load_dwordx2 v[62:63], v3, s[12:15], s60 offen offset:2304 sc1
L2_pl5:
    s_bitcmp1_b32 s30, 2
    s_cbranch_scc0 L2_pl2
    buffer_load_dwordx4 v[40:43], v1, s[12:15], s58 offen offset:0 sc1
    buffer_load_dwordx4 v[44:47], v1, s[12:15], s58 offen offset:1024 sc1
L2_pl2:
    s_bitcmp1_b32 s30, 3
    s_cbranch_scc0 L2_pl3
    buffer_load_dwordx4 v[48:51], v1, s[12:15], s59 offen offset:0 sc1
    buffer_load_dwordx4 v[52:55], v1, s[12:15], s59 offen offset:1024 sc1
L2_pl3:
    s_cmp_eq_u32 s30, 0
    s_cbranch_scc1 L2_fin
    s_waitcnt vmcnt(0)
    s_sub_u32 s29, s29, 1
    s_cbranch_scc0 L2_pass
L2_fin:
    s_mul_i32 s28, s27, 5120
    s_add_u32 s28, s28, 143360
    s_mul_i32 s31, s27, 7168
    s_add_u32 s31, s31, 66048
    s_lshl_b32 s29, s27, 11
    s_add_u32 s29, s29, 2560
    s_add_u32 s30, s28, 3072
    s_cmp_eq_u32 s26, 0
    s_cselect_b32 s28, s28, s31
    s_cselect_b32 s29, s30, s29
    v_add_u32 v2, s28, v1
    v_add_u32 v3, s29, v1
    ds_write_b128 v2, v[4:7] offset:0
    ds_write_b128 v2, v[8:11] offset:1024
    ds_write_b128 v2, v[12:15] offset:2048
    ds_write_b128 v3, v[16:19] offset:0
    ds_write_b128 v3, v[20:23] offset:1024
    s_waitcnt lgkmcnt(0)
    s_barrier
L2_end:
    s_endpgm
L2_fallback:
    v_subrev_u32 v70, 81920, v70
    v_subrev_u32 v71, 81920, v71
    v_subrev_u32 v72, 81920, v72
    v_subrev_u32 v73, 81920, v73
    v_mov_b32 v13, 0
    v_mov_b32 v162, 0xff800000
    v_mov_b32 v15, 0
    v_mov_b32 v163, 0xff800000
    s_mov_b32 s24, 0
    s_waitcnt lgkmcnt(0)
L2_fb1:
    buffer_load_dwordx4 v[16:19], v70, s[8:11], 0 offen sc1
    buffer_load_dword v20, v71, s[8:11], 0 offen offset:1024 sc1
    s_waitcnt vmcnt(0)
    v_mfma_f32_32x32x16_bf16 v[38:53], v[16:19], v[4:7], 0
    v_mfma_f32_32x32x8_bf16 v[38:53], v[20:21], v[12:13], v[38:53]
    v_mfma_f32_32x32x16_bf16 v[54:69], v[16:19], v[8:11], 0
    v_mfma_f32_32x32x8_bf16 v[54:69], v[20:21], v[14:15], v[54:69]
    v_add_u32 v70, 2560, v70
    v_add_u32 v71, 2560, v71
    s_nop 15
    v_max3_f32 v164, v38, v39, v40
    v_max3_f32 v165, v41, v42, v43
    v_max3_f32 v164, v164, v44, v45
    v_max3_f32 v165, v165, v46, v47
    v_max3_f32 v164, v164, v48, v49
    v_max3_f32 v165, v165, v50, v51
    v_max3_f32 v164, v164, v52, v53
    v_max3_f32 v162, v164, v165, v162
    v_max3_f32 v164, v54, v55, v56
    v_max3_f32 v165, v57, v58, v59
    v_max3_f32 v164, v164, v60, v61
    v_max3_f32 v165, v165, v62, v63
    v_max3_f32 v164, v164, v64, v65
    v_max3_f32 v165, v165, v66, v67
    v_max3_f32 v164, v164, v68, v69
    v_max3_f32 v163, v164, v165, v163
    s_add_u32 s24, s24, 1
    s_cmp_lt_u32 s24, 32
    s_cbranch_scc1 L2_fb1
    v_mov_b32 v165, v162
    s_nop 1
    v_permlane32_swap_b32 v162, v165
    s_nop 1
    v_max_f32 v162, v162, v165
    v_mov_b32 v104, 0
    v_mov_b32 v105, 0
    v_mov_b32 v106, 0
    v_mov_b32 v107, 0
    v_mov_b32 v108, 0
    v_mov_b32 v109, 0
    v_mov_b32 v110, 0
    v_mov_b32 v111, 0
    v_mov_b32 v112, 0
    v_mov_b32 v113, 0
    v_mov_b32 v114, 0
    v_mov_b32 v115, 0
    v_mov_b32 v116, 0
    v_mov_b32 v117, 0
    v_mov_b32 v118, 0
    v_mov_b32 v119, 0
    v_mov_b32 v165, v163
    s_nop 1
    v_permlane32_swap_b32 v163, v165
    s_nop 1
    v_max_f32 v163, v163, v165
    v_mov_b32 v120, 0
    v_mov_b32 v121, 0
    v_mov_b32 v122, 0
    v_mov_b32 v123, 0
    v_mov_b32 v124, 0
    v_mov_b32 v125, 0
    v_mov_b32 v126, 0
    v_mov_b32 v127, 0
    v_mov_b32 v128, 0
    v_mov_b32 v129, 0
    v_mov_b32 v130, 0
    v_mov_b32 v131, 0
    v_mov_b32 v132, 0
    v_mov_b32 v133, 0
    v_mov_b32 v134, 0
    v_mov_b32 v135, 0
    v_subrev_u32 v70, 81920, v70
    v_subrev_u32 v71, 81920, v71
    s_mov_b32 s24, 0
L2_fb2:
    buffer_load_dwordx4 v[16:19], v70, s[8:11], 0 offen sc1
    buffer_load_dword v20, v71, s[8:11], 0 offen offset:1024 sc1
    s_mov_b64 exec, s[20:21]
    buffer_load_dwordx4 v[22:25], v72, s[8:11], 0 offen offset:1280 sc1
    buffer_load_dwordx4 v[26:29], v73, s[8:11], 0 offen offset:1280 sc1
    s_mov_b64 exec, -1
    s_waitcnt vmcnt(0)
    v_mfma_f32_32x32x16_bf16 v[38:53], v[16:19], v[4:7], 0
    v_mfma_f32_32x32x8_bf16 v[38:53], v[20:21], v[12:13], v[38:53]
    s_nop 15
    v_sub_f32 v38, v38, v162
    v_sub_f32 v39, v39, v162
    v_sub_f32 v40, v40, v162
    v_sub_f32 v41, v41, v162
    v_sub_f32 v42, v42, v162
    v_sub_f32 v43, v43, v162
    v_sub_f32 v44, v44, v162
    v_sub_f32 v45, v45, v162
    v_sub_f32 v46, v46, v162
    v_sub_f32 v47, v47, v162
    v_sub_f32 v48, v48, v162
    v_sub_f32 v49, v49, v162
    v_sub_f32 v50, v50, v162
    v_sub_f32 v51, v51, v162
    v_sub_f32 v52, v52, v162
    v_sub_f32 v53, v53, v162
    v_exp_f32 v38, v38
    v_exp_f32 v39, v39
    v_exp_f32 v40, v40
    v_exp_f32 v41, v41
    v_exp_f32 v42, v42
    v_exp_f32 v43, v43
    v_exp_f32 v44, v44
    v_exp_f32 v45, v45
    v_exp_f32 v46, v46
    v_exp_f32 v47, v47
    v_exp_f32 v48, v48
    v_exp_f32 v49, v49
    v_exp_f32 v50, v50
    v_exp_f32 v51, v51
    v_exp_f32 v52, v52
    v_exp_f32 v53, v53
    s_nop 0
    v_cvt_pk_bf16_f32 v30, v38, v39
    v_cvt_pk_bf16_f32 v31, v40, v41
    v_cvt_pk_bf16_f32 v32, v42, v43
    v_cvt_pk_bf16_f32 v33, v44, v45
    v_cvt_pk_bf16_f32 v34, v46, v47
    v_cvt_pk_bf16_f32 v35, v48, v49
    v_cvt_pk_bf16_f32 v36, v50, v51
    v_cvt_pk_bf16_f32 v37, v52, v53
    s_nop 1
    v_mfma_f32_32x32x16_bf16 v[104:119], v[22:25], v[30:33], v[104:119]
    v_mfma_f32_32x32x16_bf16 v[104:119], v[26:29], v[34:37], v[104:119]
    v_mfma_f32_32x32x16_bf16 v[38:53], v[16:19], v[8:11], 0
    v_mfma_f32_32x32x8_bf16 v[38:53], v[20:21], v[14:15], v[38:53]
    s_nop 15
    v_sub_f32 v38, v38, v163
    v_sub_f32 v39, v39, v163
    v_sub_f32 v40, v40, v163
    v_sub_f32 v41, v41, v163
    v_sub_f32 v42, v42, v163
    v_sub_f32 v43, v43, v163
    v_sub_f32 v44, v44, v163
    v_sub_f32 v45, v45, v163
    v_sub_f32 v46, v46, v163
    v_sub_f32 v47, v47, v163
    v_sub_f32 v48, v48, v163
    v_sub_f32 v49, v49, v163
    v_sub_f32 v50, v50, v163
    v_sub_f32 v51, v51, v163
    v_sub_f32 v52, v52, v163
    v_sub_f32 v53, v53, v163
    v_exp_f32 v38, v38
    v_exp_f32 v39, v39
    v_exp_f32 v40, v40
    v_exp_f32 v41, v41
    v_exp_f32 v42, v42
    v_exp_f32 v43, v43
    v_exp_f32 v44, v44
    v_exp_f32 v45, v45
    v_exp_f32 v46, v46
    v_exp_f32 v47, v47
    v_exp_f32 v48, v48
    v_exp_f32 v49, v49
    v_exp_f32 v50, v50
    v_exp_f32 v51, v51
    v_exp_f32 v52, v52
    v_exp_f32 v53, v53
    s_nop 0
    v_cvt_pk_bf16_f32 v30, v38, v39
    v_cvt_pk_bf16_f32 v31, v40, v41
    v_cvt_pk_bf16_f32 v32, v42, v43
    v_cvt_pk_bf16_f32 v33, v44, v45
    v_cvt_pk_bf16_f32 v34, v46, v47
    v_cvt_pk_bf16_f32 v35, v48, v49
    v_cvt_pk_bf16_f32 v36, v50, v51
    v_cvt_pk_bf16_f32 v37, v52, v53
    s_nop 1
    v_mfma_f32_32x32x16_bf16 v[120:135], v[22:25], v[30:33], v[120:135]
    v_mfma_f32_32x32x16_bf16 v[120:135], v[26:29], v[34:37], v[120:135]
    v_add_u32 v70, 2560, v70
    v_add_u32 v71, 2560, v71
    v_add_u32 v72, 2560, v72
    v_add_u32 v73, 2560, v73
    s_add_u32 s24, s24, 1
    s_cmp_lt_u32 s24, 32
    s_cbranch_scc1 L2_fb2
    s_mov_b32 s25, 1
    s_branch L2_epi
L2_helper:
    s_load_dwordx4 s[56:59], s[0:1], 40
    s_load_dwordx2 s[76:77], s[0:1], 56
    s_load_dwordx2 s[62:63], s[0:1], 0
    s_load_dwordx2 s[60:61], s[0:1], 64
    v_lshlrev_b32 v1, 4, v0
    v_and_b32 v2, 7, v0
    v_lshlrev_b32 v2, 2, v2
    s_lshr_b32 s30, s18, 1
    s_mul_i32 s30, s30, 81920
    s_and_b32 s31, s18, 1
    s_lshl_b32 s31, s31, 12
    s_add_u32 s30, s30, s31
    s_mov_b32 m0, s30
    s_bfe_u32 s17, s2, 0x20005
    s_mov_b32 s17, 0
    s_mul_i32 s78, s17, 20480
    s_add_u32 s78, s78, s30
    s_sub_u32 s79, s30, s31
    s_add_u32 s79, s79, 81920
    s_mov_b32 s24, 0
    s_waitcnt lgkmcnt(0)
    s_add_u32 s8, s4, s29
    s_addc_u32 s9, s5, 0
    s_mov_b32 s12, s4
    s_mov_b32 s13, s5
    s_mov_b32 s14, 0x1100000
    s_mov_b32 s15, 0x20000
    s_mov_b32 s28, 0xb0a000
    buffer_load_dword v2, v2, s[12:15], s28 offen
    buffer_load_dwordx4 v1, s[8:11], s78 offen offset:0 lds
    buffer_load_dwordx4 v1, s[8:11], s78 offen offset:1024 lds
    buffer_load_dwordx4 v1, s[8:11], s78 offen offset:2048 lds
    buffer_load_dwordx4 v1, s[8:11], s78 offen offset:3072 lds
    s_add_u32 s78, s78, 8192
    s_cmp_ge_u32 s78, s79
    s_cselect_b32 s31, 81920, 0
    s_sub_u32 s78, s78, s31
    s_add_u32 s30, s30, 8192
    s_mov_b32 m0, s30
    s_add_u32 s24, s24, 1
    buffer_load_dwordx4 v1, s[8:11], s78 offen offset:0 lds
    buffer_load_dwordx4 v1, s[8:11], s78 offen offset:1024 lds
    buffer_load_dwordx4 v1, s[8:11], s78 offen offset:2048 lds
    buffer_load_dwordx4 v1, s[8:11], s78 offen offset:3072 lds
    s_add_u32 s78, s78, 8192
    s_cmp_ge_u32 s78, s79
    s_cselect_b32 s31, 81920, 0
    s_sub_u32 s78, s78, s31
    s_add_u32 s30, s30, 8192
    s_mov_b32 m0, s30
    s_add_u32 s24, s24, 1
    v_mul_u32_u24 v111, 3072, v0
    v_lshrrev_b32 v114, 4, v0
    v_bfe_u32 v3, v0, 2, 2
    v_lshl_add_u32 v115, v114, 3, v3
    v_lshlrev_b32 v115, 4, v115
    v_bfe_u32 v4, v0, 1, 1
    v_lshl_add_u32 v115, v4, 3, v115
    v_and_b32 v4, 1, v0
    v_mul_u32_u24 v4, 81920, v4
    v_add_u32 v115, v115, v4
    v_lshrrev_b32 v4, 5, v0
    v_lshl_add_u32 v110, v4, 2, v3
    v_mul_u32_u24 v110, 1280, v110
    v_mul_u32_u24 v3, 10240, v4
    v_and_b32 v4, 31, v0
    v_lshl_add_u32 v3, v4, 2, v3
    v_and_b32 v4, 16, v0
    v_lshl_add_u32 v110, v4, 1, v110
    v_and_b32 v4, 3, v0
    v_lshl_add_u32 v110, v4, 3, v110
    s_waitcnt vmcnt(0)
    v_mul_u32_u24 v2, 1280, v2
    v_lshl_add_u32 v2, v114, 4, v2
    s_barrier
L2_hld:
    buffer_load_dwordx4 v1, s[8:11], s78 offen offset:0 lds
    buffer_load_dwordx4 v1, s[8:11], s78 offen offset:1024 lds
    buffer_load_dwordx4 v1, s[8:11], s78 offen offset:2048 lds
    buffer_load_dwordx4 v1, s[8:11], s78 offen offset:3072 lds
    s_add_u32 s78, s78, 8192
    s_cmp_ge_u32 s78, s79
    s_cselect_b32 s31, 81920, 0
    s_sub_u32 s78, s78, s31
    s_add_u32 s30, s30, 8192
    s_mov_b32 m0, s30
    s_add_u32 s24, s24, 1
    s_cmp_lt_u32 s24, 10
    s_cbranch_scc1 L2_hld
    s_lshr_b32 s27, s2, 3
    s_and_b32 s26, s2, 7
    s_mul_i32 s25, s26, 24
    s_add_u32 s25, s25, s27
    s_mov_b32 s64, s56
    s_mov_b32 s65, s57
    s_mov_b32 s66, 0x1e0000
    s_mov_b32 s67, 0x20000
    s_mov_b32 s68, s58
    s_mov_b32 s69, s59
    s_mov_b32 s70, 0x1e0000
    s_mov_b32 s71, 0x20000
    s_mov_b32 s72, s76
    s_mov_b32 s73, s77
    s_mov_b32 s74, 0x1e0000
    s_mov_b32 s75, 0x20000
    s_waitcnt vmcnt(0)
    s_barrier
    s_setprio 3
    s_and_b32 s28, s27, 3
    s_cmp_lg_u32 s28, s18
    s_cbranch_scc1 L2_hwarm
    s_cmp_ge_u32 s2, 192
    s_cbranch_scc1 L2_hend
    s_lshl_b32 s29, s25, 4
    s_and_b32 s30, s27, 7
    s_mov_b32 s24, 10
L2_hgu:
    s_mul_i32 s31, s30, 196608
    s_add_u32 s31, s31, s29
    s_lshl_b32 s32, s30, 10
    s_mov_b32 m0, s32
    s_add_u32 s32, s32, 81920
    buffer_load_dwordx4 v111, s[64:67], s31 offen lds
    s_mov_b32 m0, s32
    s_add_u32 s30, s30, 1
    buffer_load_dwordx4 v111, s[68:71], s31 offen lds
    s_cmp_eq_u32 s30, 10
    s_cselect_b32 s30, 0, s30
    s_sub_u32 s24, s24, 1
    s_cmp_lg_u32 s24, 0
    s_cbranch_scc1 L2_hgu
    s_mov_b32 s28, 0xd80000
    buffer_load_dwordx4 v[4:7], v2, s[12:15], s28 offen offset:0
    buffer_load_dwordx4 v[8:11], v2, s[12:15], s28 offen offset:64
    buffer_load_dwordx4 v[12:15], v2, s[12:15], s28 offen offset:128
    buffer_load_dwordx4 v[16:19], v2, s[12:15], s28 offen offset:192
    buffer_load_dwordx4 v[20:23], v2, s[12:15], s28 offen offset:256
    buffer_load_dwordx4 v[24:27], v2, s[12:15], s28 offen offset:320
    buffer_load_dwordx4 v[28:31], v2, s[12:15], s28 offen offset:384
    buffer_load_dwordx4 v[32:35], v2, s[12:15], s28 offen offset:448
    buffer_load_dwordx4 v[36:39], v2, s[12:15], s28 offen offset:512
    buffer_load_dwordx4 v[40:43], v2, s[12:15], s28 offen offset:576
    buffer_load_dwordx4 v[44:47], v2, s[12:15], s28 offen offset:640
    buffer_load_dwordx4 v[48:51], v2, s[12:15], s28 offen offset:704
    buffer_load_dwordx4 v[52:55], v2, s[12:15], s28 offen offset:768
    buffer_load_dwordx4 v[56:59], v2, s[12:15], s28 offen offset:832
    buffer_load_dwordx4 v[60:63], v2, s[12:15], s28 offen offset:896
    buffer_load_dwordx4 v[64:67], v2, s[12:15], s28 offen offset:960
    buffer_load_dwordx4 v[68:71], v2, s[12:15], s28 offen offset:1024
    buffer_load_dwordx4 v[72:75], v2, s[12:15], s28 offen offset:1088
    buffer_load_dwordx4 v[76:79], v2, s[12:15], s28 offen offset:1152
    buffer_load_dwordx4 v[80:83], v2, s[12:15], s28 offen offset:1216
    s_waitcnt vmcnt(0)
    ds_read_b64_tr_b16 v[84:85], v115 offset:0
    ds_read_b64_tr_b16 v[86:87], v115 offset:64
    s_waitcnt lgkmcnt(0)
    v_mfma_f32_16x16x32_bf16 v[104:107], v[84:87], v[4:7], 0
    ds_read_b64_tr_b16 v[88:89], v115 offset:512
    ds_read_b64_tr_b16 v[90:91], v115 offset:576
    s_waitcnt lgkmcnt(0)
    v_mfma_f32_16x16x32_bf16 v[104:107], v[88:91], v[8:11], v[104:107]
    ds_read_b64_tr_b16 v[84:85], v115 offset:1024
    ds_read_b64_tr_b16 v[86:87], v115 offset:1088
    s_waitcnt lgkmcnt(0)
    v_mfma_f32_16x16x32_bf16 v[104:107], v[84:87], v[12:15], v[104:107]
    ds_read_b64_tr_b16 v[88:89], v115 offset:1536
    ds_read_b64_tr_b16 v[90:91], v115 offset:1600
    s_waitcnt lgkmcnt(0)
    v_mfma_f32_16x16x32_bf16 v[104:107], v[88:91], v[16:19], v[104:107]
    ds_read_b64_tr_b16 v[84:85], v115 offset:2048
    ds_read_b64_tr_b16 v[86:87], v115 offset:2112
    s_waitcnt lgkmcnt(0)
    v_mfma_f32_16x16x32_bf16 v[104:107], v[84:87], v[20:23], v[104:107]
    ds_read_b64_tr_b16 v[88:89], v115 offset:2560
    ds_read_b64_tr_b16 v[90:91], v115 offset:2624
    s_waitcnt lgkmcnt(0)
    v_mfma_f32_16x16x32_bf16 v[104:107], v[88:91], v[24:27], v[104:107]
    ds_read_b64_tr_b16 v[84:85], v115 offset:3072
    ds_read_b64_tr_b16 v[86:87], v115 offset:3136
    s_waitcnt lgkmcnt(0)
    v_mfma_f32_16x16x32_bf16 v[104:107], v[84:87], v[28:31], v[104:107]
    ds_read_b64_tr_b16 v[88:89], v115 offset:3584
    ds_read_b64_tr_b16 v[90:91], v115 offset:3648
    s_waitcnt lgkmcnt(0)
    v_mfma_f32_16x16x32_bf16 v[104:107], v[88:91], v[32:35], v[104:107]
    ds_read_b64_tr_b16 v[84:85], v115 offset:4096
    ds_read_b64_tr_b16 v[86:87], v115 offset:4160
    s_waitcnt lgkmcnt(0)
    v_mfma_f32_16x16x32_bf16 v[104:107], v[84:87], v[36:39], v[104:107]
    ds_read_b64_tr_b16 v[88:89], v115 offset:4608
    ds_read_b64_tr_b16 v[90:91], v115 offset:4672
    s_waitcnt lgkmcnt(0)
    v_mfma_f32_16x16x32_bf16 v[104:107], v[88:91], v[40:43], v[104:107]
    ds_read_b64_tr_b16 v[84:85], v115 offset:5120
    ds_read_b64_tr_b16 v[86:87], v115 offset:5184
    s_waitcnt lgkmcnt(0)
    v_mfma_f32_16x16x32_bf16 v[104:107], v[84:87], v[44:47], v[104:107]
    ds_read_b64_tr_b16 v[88:89], v115 offset:5632
    ds_read_b64_tr_b16 v[90:91], v115 offset:5696
    s_waitcnt lgkmcnt(0)
    v_mfma_f32_16x16x32_bf16 v[104:107], v[88:91], v[48:51], v[104:107]
    ds_read_b64_tr_b16 v[84:85], v115 offset:6144
    ds_read_b64_tr_b16 v[86:87], v115 offset:6208
    s_waitcnt lgkmcnt(0)
    v_mfma_f32_16x16x32_bf16 v[104:107], v[84:87], v[52:55], v[104:107]
    ds_read_b64_tr_b16 v[88:89], v115 offset:6656
    ds_read_b64_tr_b16 v[90:91], v115 offset:6720
    s_waitcnt lgkmcnt(0)
    v_mfma_f32_16x16x32_bf16 v[104:107], v[88:91], v[56:59], v[104:107]
    ds_read_b64_tr_b16 v[84:85], v115 offset:7168
    ds_read_b64_tr_b16 v[86:87], v115 offset:7232
    s_waitcnt lgkmcnt(0)
    v_mfma_f32_16x16x32_bf16 v[104:107], v[84:87], v[60:63], v[104:107]
    ds_read_b64_tr_b16 v[88:89], v115 offset:7680
    ds_read_b64_tr_b16 v[90:91], v115 offset:7744
    s_waitcnt lgkmcnt(0)
    v_mfma_f32_16x16x32_bf16 v[104:107], v[88:91], v[64:67], v[104:107]
    ds_read_b64_tr_b16 v[84:85], v115 offset:8192
    ds_read_b64_tr_b16 v[86:87], v115 offset:8256
    s_waitcnt lgkmcnt(0)
    v_mfma_f32_16x16x32_bf16 v[104:107], v[84:87], v[68:71], v[104:107]
    ds_read_b64_tr_b16 v[88:89], v115 offset:8704
    ds_read_b64_tr_b16 v[90:91], v115 offset:8768
    s_waitcnt lgkmcnt(0)
    v_mfma_f32_16x16x32_bf16 v[104:107], v[88:91], v[72:75], v[104:107]
    ds_read_b64_tr_b16 v[84:85], v115 offset:9216
    ds_read_b64_tr_b16 v[86:87], v115 offset:9280
    s_waitcnt lgkmcnt(0)
    v_mfma_f32_16x16x32_bf16 v[104:107], v[84:87], v[76:79], v[104:107]
    ds_read_b64_tr_b16 v[88:89], v115 offset:9728
    ds_read_b64_tr_b16 v[90:91], v115 offset:9792
    s_waitcnt lgkmcnt(0)
    v_mfma_f32_16x16x32_bf16 v[104:107], v[88:91], v[80:83], v[104:107]
    s_mul_i32 s31, s25, 10240
    s_mov_b32 m0, 0
    s_nop 0
    buffer_load_dwordx4 v1, s[72:75], s31 offen offset:0 lds
    buffer_load_dwordx4 v1, s[72:75], s31 offen offset:1024 lds
    buffer_load_dwordx4 v1, s[72:75], s31 offen offset:2048 lds
    buffer_load_dwordx4 v1, s[72:75], s31 offen offset:3072 lds
    s_mov_b32 m0, 4096
    s_add_u32 s31, s31, 4096
    buffer_load_dwordx4 v1, s[72:75], s31 offen offset:0 lds
    buffer_load_dwordx4 v1, s[72:75], s31 offen offset:1024 lds
    buffer_load_dwordx4 v1, s[72:75], s31 offen offset:2048 lds
    buffer_load_dwordx4 v1, s[72:75], s31 offen offset:3072 lds
    s_mov_b32 m0, 8192
    s_add_u32 s31, s31, 4096
    buffer_load_dwordx4 v1, s[72:75], s31 offen offset:0 lds
    buffer_load_dwordx4 v1, s[72:75], s31 offen offset:1024 lds
    v_cvt_pk_bf16_f32 v112, v104, v105
    v_cvt_pk_bf16_f32 v113, v106, v107
    v_mov_b32 v108, v112
    v_mov_b32 v109, v113
    s_nop 0
    v_permlane16_swap_b32 v112, v108
    v_permlane16_swap_b32 v113, v109
    v_lshlrev_b32 v104, 16, v112
    v_and_b32 v105, 0xffff0000, v112
    v_lshlrev_b32 v106, 16, v113
    v_and_b32 v107, 0xffff0000, v113
    v_mul_f32 v4, 0xbfb8aa3b, v104
    v_mul_f32 v5, 0xbfb8aa3b, v105
    v_mul_f32 v6, 0xbfb8aa3b, v106
    v_mul_f32 v7, 0xbfb8aa3b, v107
    v_exp_f32 v4, v4
    v_exp_f32 v5, v5
    v_exp_f32 v6, v6
    v_exp_f32 v7, v7
    v_add_f32 v4, 1.0, v4
    v_add_f32 v5, 1.0, v5
    v_add_f32 v6, 1.0, v6
    v_add_f32 v7, 1.0, v7
    v_rcp_f32 v4, v4
    v_rcp_f32 v5, v5
    v_rcp_f32 v6, v6
    v_rcp_f32 v7, v7
    v_mul_f32 v104, v104, v4
    v_mul_f32 v105, v105, v5
    v_mul_f32 v106, v106, v6
    v_mul_f32 v107, v107, v7
    v_cvt_pk_bf16_f32 v112, v104, v105
    v_cvt_pk_bf16_f32 v113, v106, v107
    v_lshlrev_b32 v104, 16, v112
    v_and_b32 v105, 0xffff0000, v112
    v_lshlrev_b32 v4, 16, v108
    v_and_b32 v5, 0xffff0000, v108
    v_lshlrev_b32 v106, 16, v113
    v_and_b32 v107, 0xffff0000, v113
    v_lshlrev_b32 v6, 16, v109
    v_and_b32 v7, 0xffff0000, v109
    v_mul_f32 v104, v104, v4
    v_mul_f32 v105, v105, v5
    v_mul_f32 v106, v106, v6
    v_mul_f32 v107, v107, v7
    v_cvt_pk_bf16_f32 v112, v104, v105
    v_cvt_pk_bf16_f32 v113, v106, v107
    s_mul_i32 s24, s26, 20480
    s_add_u32 s28, s24, 0xd00000
    s_add_u32 s29, s24, 0xd00a00
    s_add_u32 s30, s24, 0xd01400
    s_add_u32 s31, s24, 0xd01e00
    s_waitcnt vmcnt(0)
    ds_read_b64_tr_b16 v[84:85], v110 offset:0
    s_waitcnt lgkmcnt(0)
    v_mfma_f32_32x32x8_bf16 v[4:19], v[112:113], v[84:85], 0
    ds_read_b64_tr_b16 v[86:87], v110 offset:64
    s_waitcnt lgkmcnt(0)
    v_mfma_f32_32x32x8_bf16 v[20:35], v[112:113], v[86:87], 0
    s_nop 7
    ds_read_b64_tr_b16 v[84:85], v110 offset:128
    s_waitcnt lgkmcnt(0)
    v_mfma_f32_32x32x8_bf16 v[36:51], v[112:113], v[84:85], 0
    s_nop 1
    buffer_atomic_add_f32 v4, v3, s[12:15], s28 offen offset:0
    buffer_atomic_add_f32 v5, v3, s[12:15], s29 offen offset:0
    buffer_atomic_add_f32 v6, v3, s[12:15], s30 offen offset:0
    buffer_atomic_add_f32 v7, v3, s[12:15], s31 offen offset:0
    ds_read_b64_tr_b16 v[86:87], v110 offset:192
    s_waitcnt lgkmcnt(0)
    v_mfma_f32_32x32x8_bf16 v[4:19], v[112:113], v[86:87], 0
    s_nop 1
    buffer_atomic_add_f32 v20, v3, s[12:15], s28 offen offset:128
    buffer_atomic_add_f32 v21, v3, s[12:15], s29 offen offset:128
    buffer_atomic_add_f32 v22, v3, s[12:15], s30 offen offset:128
    buffer_atomic_add_f32 v23, v3, s[12:15], s31 offen offset:128
    ds_read_b64_tr_b16 v[84:85], v110 offset:256
    s_waitcnt lgkmcnt(0)
    v_mfma_f32_32x32x8_bf16 v[20:35], v[112:113], v[84:85], 0
    s_nop 1
    buffer_atomic_add_f32 v36, v3, s[12:15], s28 offen offset:256
    buffer_atomic_add_f32 v37, v3, s[12:15], s29 offen offset:256
    buffer_atomic_add_f32 v38, v3, s[12:15], s30 offen offset:256
    buffer_atomic_add_f32 v39, v3, s[12:15], s31 offen offset:256
    ds_read_b64_tr_b16 v[86:87], v110 offset:320
    s_waitcnt lgkmcnt(0)
    v_mfma_f32_32x32x8_bf16 v[36:51], v[112:113], v[86:87], 0
    s_nop 1
    buffer_atomic_add_f32 v4, v3, s[12:15], s28 offen offset:384
    buffer_atomic_add_f32 v5, v3, s[12:15], s29 offen offset:384
    buffer_atomic_add_f32 v6, v3, s[12:15], s30 offen offset:384
    buffer_atomic_add_f32 v7, v3, s[12:15], s31 offen offset:384
    ds_read_b64_tr_b16 v[84:85], v110 offset:384
    s_waitcnt lgkmcnt(0)
    v_mfma_f32_32x32x8_bf16 v[4:19], v[112:113], v[84:85], 0
    s_nop 1
    buffer_atomic_add_f32 v20, v3, s[12:15], s28 offen offset:512
    buffer_atomic_add_f32 v21, v3, s[12:15], s29 offen offset:512
    buffer_atomic_add_f32 v22, v3, s[12:15], s30 offen offset:512
    buffer_atomic_add_f32 v23, v3, s[12:15], s31 offen offset:512
    ds_read_b64_tr_b16 v[86:87], v110 offset:448
    s_waitcnt lgkmcnt(0)
    v_mfma_f32_32x32x8_bf16 v[20:35], v[112:113], v[86:87], 0
    s_nop 1
    buffer_atomic_add_f32 v36, v3, s[12:15], s28 offen offset:640
    buffer_atomic_add_f32 v37, v3, s[12:15], s29 offen offset:640
    buffer_atomic_add_f32 v38, v3, s[12:15], s30 offen offset:640
    buffer_atomic_add_f32 v39, v3, s[12:15], s31 offen offset:640
    ds_read_b64_tr_b16 v[84:85], v110 offset:512
    s_waitcnt lgkmcnt(0)
    v_mfma_f32_32x32x8_bf16 v[36:51], v[112:113], v[84:85], 0
    s_nop 1
    buffer_atomic_add_f32 v4, v3, s[12:15], s28 offen offset:768
    buffer_atomic_add_f32 v5, v3, s[12:15], s29 offen offset:768
    buffer_atomic_add_f32 v6, v3, s[12:15], s30 offen offset:768
    buffer_atomic_add_f32 v7, v3, s[12:15], s31 offen offset:768
    ds_read_b64_tr_b16 v[86:87], v110 offset:576
    s_waitcnt lgkmcnt(0)
    v_mfma_f32_32x32x8_bf16 v[4:19], v[112:113], v[86:87], 0
    s_nop 1
    buffer_atomic_add_f32 v20, v3, s[12:15], s28 offen offset:896
    buffer_atomic_add_f32 v21, v3, s[12:15], s29 offen offset:896
    buffer_atomic_add_f32 v22, v3, s[12:15], s30 offen offset:896
    buffer_atomic_add_f32 v23, v3, s[12:15], s31 offen offset:896
    ds_read_b64_tr_b16 v[84:85], v110 offset:640
    s_waitcnt lgkmcnt(0)
    v_mfma_f32_32x32x8_bf16 v[20:35], v[112:113], v[84:85], 0
    s_nop 1
    buffer_atomic_add_f32 v36, v3, s[12:15], s28 offen offset:1024
    buffer_atomic_add_f32 v37, v3, s[12:15], s29 offen offset:1024
    buffer_atomic_add_f32 v38, v3, s[12:15], s30 offen offset:1024
    buffer_atomic_add_f32 v39, v3, s[12:15], s31 offen offset:1024
    ds_read_b64_tr_b16 v[86:87], v110 offset:704
    s_waitcnt lgkmcnt(0)
    v_mfma_f32_32x32x8_bf16 v[36:51], v[112:113], v[86:87], 0
    s_nop 1
    buffer_atomic_add_f32 v4, v3, s[12:15], s28 offen offset:1152
    buffer_atomic_add_f32 v5, v3, s[12:15], s29 offen offset:1152
    buffer_atomic_add_f32 v6, v3, s[12:15], s30 offen offset:1152
    buffer_atomic_add_f32 v7, v3, s[12:15], s31 offen offset:1152
    ds_read_b64_tr_b16 v[84:85], v110 offset:768
    s_waitcnt lgkmcnt(0)
    v_mfma_f32_32x32x8_bf16 v[4:19], v[112:113], v[84:85], 0
    s_nop 1
    buffer_atomic_add_f32 v20, v3, s[12:15], s28 offen offset:1280
    buffer_atomic_add_f32 v21, v3, s[12:15], s29 offen offset:1280
    buffer_atomic_add_f32 v22, v3, s[12:15], s30 offen offset:1280
    buffer_atomic_add_f32 v23, v3, s[12:15], s31 offen offset:1280
    ds_read_b64_tr_b16 v[86:87], v110 offset:832
    s_waitcnt lgkmcnt(0)
    v_mfma_f32_32x32x8_bf16 v[20:35], v[112:113], v[86:87], 0
    s_nop 1
    buffer_atomic_add_f32 v36, v3, s[12:15], s28 offen offset:1408
    buffer_atomic_add_f32 v37, v3, s[12:15], s29 offen offset:1408
    buffer_atomic_add_f32 v38, v3, s[12:15], s30 offen offset:1408
    buffer_atomic_add_f32 v39, v3, s[12:15], s31 offen offset:1408
    ds_read_b64_tr_b16 v[84:85], v110 offset:896
    s_waitcnt lgkmcnt(0)
    v_mfma_f32_32x32x8_bf16 v[36:51], v[112:113], v[84:85], 0
    s_nop 1
    buffer_atomic_add_f32 v4, v3, s[12:15], s28 offen offset:1536
    buffer_atomic_add_f32 v5, v3, s[12:15], s29 offen offset:1536
    buffer_atomic_add_f32 v6, v3, s[12:15], s30 offen offset:1536
    buffer_atomic_add_f32 v7, v3, s[12:15], s31 offen offset:1536
    ds_read_b64_tr_b16 v[86:87], v110 offset:960
    s_waitcnt lgkmcnt(0)
    v_mfma_f32_32x32x8_bf16 v[4:19], v[112:113], v[86:87], 0
    s_nop 1
    buffer_atomic_add_f32 v20, v3, s[12:15], s28 offen offset:1664
    buffer_atomic_add_f32 v21, v3, s[12:15], s29 offen offset:1664
    buffer_atomic_add_f32 v22, v3, s[12:15], s30 offen offset:1664
    buffer_atomic_add_f32 v23, v3, s[12:15], s31 offen offset:1664
    ds_read_b64_tr_b16 v[84:85], v110 offset:1024
    s_waitcnt lgkmcnt(0)
    v_mfma_f32_32x32x8_bf16 v[20:35], v[112:113], v[84:85], 0
    s_nop 1
    buffer_atomic_add_f32 v36, v3, s[12:15], s28 offen offset:1792
    buffer_atomic_add_f32 v37, v3, s[12:15], s29 offen offset:1792
    buffer_atomic_add_f32 v38, v3, s[12:15], s30 offen offset:1792
    buffer_atomic_add_f32 v39, v3, s[12:15], s31 offen offset:1792
    ds_read_b64_tr_b16 v[86:87], v110 offset:1088
    s_waitcnt lgkmcnt(0)
    v_mfma_f32_32x32x8_bf16 v[36:51], v[112:113], v[86:87], 0
    s_nop 1
    buffer_atomic_add_f32 v4, v3, s[12:15], s28 offen offset:1920
    buffer_atomic_add_f32 v5, v3, s[12:15], s29 offen offset:1920
    buffer_atomic_add_f32 v6, v3, s[12:15], s30 offen offset:1920
    buffer_atomic_add_f32 v7, v3, s[12:15], s31 offen offset:1920
    ds_read_b64_tr_b16 v[84:85], v110 offset:1152
    s_waitcnt lgkmcnt(0)
    v_mfma_f32_32x32x8_bf16 v[4:19], v[112:113], v[84:85], 0
    s_nop 1
    buffer_atomic_add_f32 v20, v3, s[12:15], s28 offen offset:2048
    buffer_atomic_add_f32 v21, v3, s[12:15], s29 offen offset:2048
    buffer_atomic_add_f32 v22, v3, s[12:15], s30 offen offset:2048
    buffer_atomic_add_f32 v23, v3, s[12:15], s31 offen offset:2048
    ds_read_b64_tr_b16 v[86:87], v110 offset:1216
    s_waitcnt lgkmcnt(0)
    v_mfma_f32_32x32x8_bf16 v[20:35], v[112:113], v[86:87], 0
    s_nop 1
    buffer_atomic_add_f32 v36, v3, s[12:15], s28 offen offset:2176
    buffer_atomic_add_f32 v37, v3, s[12:15], s29 offen offset:2176
    buffer_atomic_add_f32 v38, v3, s[12:15], s30 offen offset:2176
    buffer_atomic_add_f32 v39, v3, s[12:15], s31 offen offset:2176
    s_nop 3
    s_nop 1
    buffer_atomic_add_f32 v4, v3, s[12:15], s28 offen offset:2304
    buffer_atomic_add_f32 v5, v3, s[12:15], s29 offen offset:2304
    buffer_atomic_add_f32 v6, v3, s[12:15], s30 offen offset:2304
    buffer_atomic_add_f32 v7, v3, s[12:15], s31 offen offset:2304
    s_nop 3
    s_nop 1
    buffer_atomic_add_f32 v20, v3, s[12:15], s28 offen offset:2432
    buffer_atomic_add_f32 v21, v3, s[12:15], s29 offen offset:2432
    buffer_atomic_add_f32 v22, v3, s[12:15], s30 offen offset:2432
    buffer_atomic_add_f32 v23, v3, s[12:15], s31 offen offset:2432
    s_lshl_b32 s28, s2, 7
    s_add_u32 s28, s28, 0xc08000
    v_mov_b32 v2, 0
    v_mov_b32 v3, 1
    s_waitcnt vmcnt(0)
    s_mov_b64 exec, 1
    buffer_store_dword v3, v2, s[12:15], s28 offen sc1
    s_mov_b64 exec, -1
    s_branch L2_hend
L2_hwarm:
    s_sub_u32 s25, s18, s28
    s_sub_u32 s25, s25, 1
    s_and_b32 s25, s25, 3
    s_cmp_lg_u32 s25, 1
    s_cbranch_scc1 L2_hnofill
    v_mov_b32 v4, -1
    v_mov_b32 v5, -1
    v_mov_b32 v6, -1
    v_mov_b32 v7, -1
    v_lshrrev_b32 v2, 5, v0
    v_lshlrev_b32 v2, 14, v2
    v_and_b32 v3, 31, v0
    v_lshl_add_u32 v2, v3, 4, v2
    v_lshrrev_b32 v3, 4, v0
    v_lshlrev_b32 v3, 13, v3
    v_and_b32 v8, 15, v0
    v_lshl_add_u32 v3, v8, 4, v3
    s_lshr_b32 s28, s2, 5
    s_lshl_b32 s29, s28, 18
    s_lshl_b32 s30, s16, 9
    s_add_u32 s29, s29, s30
    s_add_u32 s29, s29, 0x780000
    buffer_store_dwordx4 v[4:7], v2, s[12:15], s29 offen sc1
    s_add_u32 s29, s29, 32768
    buffer_store_dwordx4 v[4:7], v2, s[12:15], s29 offen sc1
    s_add_u32 s29, s29, 32768
    buffer_store_dwordx4 v[4:7], v2, s[12:15], s29 offen sc1
    s_add_u32 s29, s29, 32768
    buffer_store_dwordx4 v[4:7], v2, s[12:15], s29 offen sc1
    s_add_u32 s29, s29, 32768
    buffer_store_dwordx4 v[4:7], v2, s[12:15], s29 offen sc1
    s_add_u32 s29, s29, 32768
    buffer_store_dwordx4 v[4:7], v2, s[12:15], s29 offen sc1
    s_add_u32 s29, s29, 32768
    buffer_store_dwordx4 v[4:7], v2, s[12:15], s29 offen sc1
    s_add_u32 s29, s29, 32768
    buffer_store_dwordx4 v[4:7], v2, s[12:15], s29 offen sc1
    s_lshl_b32 s29, s28, 16
    s_lshl_b32 s30, s16, 8
    s_add_u32 s29, s29, s30
    s_add_u32 s29, s29, 0x980000
    s_add_u32 s30, s29, 32768
    buffer_store_dwordx4 v[4:7], v3, s[12:15], s29 offen sc1
    buffer_store_dwordx4 v[4:7], v3, s[12:15], s30 offen sc1
    s_lshl_b32 s28, s2, 7
    s_add_u32 s28, s28, 0xc00000
    v_mov_b32 v2, 0
    s_waitcnt vmcnt(0)
    s_mov_b64 exec, 1
    buffer_store_dword v4, v2, s[12:15], s28 offen sc1
    s_mov_b64 exec, -1
L2_hnofill:
    s_and_b32 s20, s2, 7
    s_lshl_b32 s20, s20, 2
    s_lshr_b32 s28, s2, 6
    s_add_u32 s20, s20, s28
    s_bfe_u32 s21, s2, 0x30003
    s_add_u32 s36, s4, 0xb0a000
    s_addc_u32 s37, s5, 0
    s_load_dwordx8 s[64:71], s[36:37], 0
    s_mul_i32 s38, s21, 102400
    s_add_u32 s38, s38, 0xa00000
    v_lshlrev_b32 v2, 7, v0
    s_lshr_b32 s28, s2, 6
    s_mul_i32 s28, s28, 25600
    s_mul_i32 s29, s25, 12800
    s_add_u32 s28, s28, s29
    s_add_u32 s28, s28, s38
    s_add_u32 s29, s28, 4608
    s_cmp_eq_u32 s25, 2
    s_cbranch_scc1 L2_hx
    buffer_load_dword v4, v2, s[12:15], s28 offen
    buffer_load_dword v4, v2, s[12:15], s29 offen
    s_branch L2_hx1
L2_hx:
    v_and_b32 v2, 31, v0
    v_lshlrev_b32 v2, 7, v2
    s_lshr_b32 s28, s20, 2
    s_lshl_b32 s28, s28, 12
    s_add_u32 s28, s28, 0xc00000
    s_mov_b32 s29, 262144
L2_hp2:
    s_sleep 32
    buffer_load_dword v4, v2, s[12:15], s28 offen sc1
    s_sub_u32 s29, s29, 1
    s_cbranch_scc1 L2_hp2d
    s_waitcnt vmcnt(0)
    v_cmp_eq_u32 vcc, 0, v4
    s_cbranch_vccnz L2_hp2
L2_hp2d:
L2_hx1:
    v_and_b32 v2, 3, v0
    v_lshlrev_b32 v2, 2, v2
    s_mov_b32 s27, 0
L2_hph:
    s_lshl_b32 s29, s27, 3
    s_lshr_b32 s28, 0x511e3200, s29
    s_and_b32 s28, s28, 255
    s_lshr_b32 s26, 0x6432511e, s29
    s_and_b32 s26, s26, 255
    s_add_u32 s28, s28, s25
    s_mov_b32 s29, 262144
L2_hwait:
    ds_read_b32 v3, v2 offset:10240
    s_sub_u32 s29, s29, 1
    s_cbranch_scc1 L2_hw
    s_waitcnt lgkmcnt(0)
    v_cmp_ne_u32 vcc, 0xffff7fff, v3
    s_cbranch_vccz L2_hw
    s_sleep 8
    s_branch L2_hwait
L2_hw:
    s_lshl_b32 s29, s28, 10
    s_add_u32 s29, s29, s38
    s_cmp_ge_u32 s28, 50
    s_cselect_b32 s30, 29696, 0
    s_lshl_b32 s31, s28, 10
    s_add_u32 s30, s30, s31
    s_add_u32 m0, s30, 11264
    s_add_u32 s28, s28, 3
    buffer_load_dwordx4 v1, s[12:15], s29 offen lds
    s_cmp_lt_u32 s28, s26
    s_cbranch_scc1 L2_hw
    v_add_u32 v2, 16, v2
    s_add_u32 s27, s27, 1
    s_cmp_lt_u32 s27, 4
    s_cbranch_scc1 L2_hph
    s_cmp_lg_u32 s25, 0
    s_cbranch_scc1 L2_hdone
    s_mov_b32 s28, 0
    s_lshr_b32 s29, s64, 6
    s_cmp_eq_u32 s29, s20
    s_cselect_b32 s28, 1, s28
    s_lshr_b32 s29, s65, 6
    s_cmp_eq_u32 s29, s20
    s_cselect_b32 s28, 1, s28
    s_lshr_b32 s29, s66, 6
    s_cmp_eq_u32 s29, s20
    s_cselect_b32 s28, 1, s28
    s_lshr_b32 s29, s67, 6
    s_cmp_eq_u32 s29, s20
    s_cselect_b32 s28, 1, s28
    s_lshr_b32 s29, s68, 6
    s_cmp_eq_u32 s29, s20
    s_cselect_b32 s28, 1, s28
    s_lshr_b32 s29, s69, 6
    s_cmp_eq_u32 s29, s20
    s_cselect_b32 s28, 1, s28
    s_lshr_b32 s29, s70, 6
    s_cmp_eq_u32 s29, s20
    s_cselect_b32 s28, 1, s28
    s_lshr_b32 s29, s71, 6
    s_cmp_eq_u32 s29, s20
    s_cselect_b32 s28, 1, s28
    s_cmp_eq_u32 s28, 0
    s_cbranch_scc1 L2_hdone
    v_lshlrev_b32 v2, 7, v0
    s_mov_b32 s30, 0xc08000
    s_mov_b32 s31, 0xc0a000
    s_mov_b32 s32, 0xc0c000
    s_mov_b32 s29, 262144
L2_hpoll:
    buffer_load_dword v4, v2, s[12:15], s30 offen sc1
    buffer_load_dword v5, v2, s[12:15], s31 offen sc1
    buffer_load_dword v6, v2, s[12:15], s32 offen sc1
    s_sub_u32 s29, s29, 1
    s_cbranch_scc1 L2_hpolled
    s_waitcnt vmcnt(0)
    v_min3_u32 v4, v4, v5, v6
    v_cmp_eq_u32 vcc, 0, v4
    s_cbranch_vccz L2_hpolled
    s_sleep 8
    s_branch L2_hpoll
L2_hpolled:
    v_lshrrev_b32 v2, 3, v0
    v_and_b32 v3, 7, v0
    v_lshlrev_b32 v3, 4, v3
    v_mul_u32_u24 v100, 2560, v2
    v_add_u32 v100, v100, v3
    v_mul_u32_u24 v101, 320, v2
    v_add_u32 v101, v101, v3
    s_mul_i32 s28, s21, 320
    s_add_u32 s28, s28, 0xd00000
    buffer_load_dwordx4 v[4:7], v100, s[12:15], s28 offen offset:0 sc1
    buffer_load_dwordx4 v[8:11], v100, s[12:15], s28 offen offset:128 sc1
    buffer_load_dwordx4 v[12:15], v100, s[12:15], s28 offen offset:256 sc1
    s_add_u32 s28, s28, 20480
    buffer_load_dwordx4 v[16:19], v100, s[12:15], s28 offen offset:0 sc1
    buffer_load_dwordx4 v[20:23], v100, s[12:15], s28 offen offset:128 sc1
    buffer_load_dwordx4 v[24:27], v100, s[12:15], s28 offen offset:256 sc1
    s_add_u32 s28, s28, 20480
    buffer_load_dwordx4 v[28:31], v100, s[12:15], s28 offen offset:0 sc1
    buffer_load_dwordx4 v[32:35], v100, s[12:15], s28 offen offset:128 sc1
    buffer_load_dwordx4 v[36:39], v100, s[12:15], s28 offen offset:256 sc1
    s_add_u32 s28, s28, 20480
    buffer_load_dwordx4 v[40:43], v100, s[12:15], s28 offen offset:0 sc1
    buffer_load_dwordx4 v[44:47], v100, s[12:15], s28 offen offset:128 sc1
    buffer_load_dwordx4 v[48:51], v100, s[12:15], s28 offen offset:256 sc1
    s_add_u32 s28, s28, 20480
    buffer_load_dwordx4 v[52:55], v100, s[12:15], s28 offen offset:0 sc1
    buffer_load_dwordx4 v[56:59], v100, s[12:15], s28 offen offset:128 sc1
    buffer_load_dwordx4 v[60:63], v100, s[12:15], s28 offen offset:256 sc1
    s_add_u32 s28, s28, 20480
    buffer_load_dwordx4 v[64:67], v100, s[12:15], s28 offen offset:0 sc1
    buffer_load_dwordx4 v[68:71], v100, s[12:15], s28 offen offset:128 sc1
    buffer_load_dwordx4 v[72:75], v100, s[12:15], s28 offen offset:256 sc1
    s_add_u32 s28, s28, 20480
    buffer_load_dwordx4 v[76:79], v100, s[12:15], s28 offen offset:0 sc1
    buffer_load_dwordx4 v[80:83], v100, s[12:15], s28 offen offset:128 sc1
    buffer_load_dwordx4 v[84:87], v100, s[12:15], s28 offen offset:256 sc1
    s_add_u32 s28, s28, 20480
    buffer_load_dwordx4 v[88:91], v100, s[12:15], s28 offen offset:0 sc1
    buffer_load_dwordx4 v[92:95], v100, s[12:15], s28 offen offset:128 sc1
    buffer_load_dwordx4 v[96:99], v100, s[12:15], s28 offen offset:256 sc1
    v_cmp_gt_u32 vcc, 64, v3
    s_waitcnt vmcnt(0)
    v_pk_add_f32 v[4:5], v[4:5], v[16:17]
    v_pk_add_f32 v[6:7], v[6:7], v[18:19]
    v_pk_add_f32 v[8:9], v[8:9], v[20:21]
    v_pk_add_f32 v[10:11], v[10:11], v[22:23]
    v_pk_add_f32 v[12:13], v[12:13], v[24:25]
    v_pk_add_f32 v[14:15], v[14:15], v[26:27]
    v_pk_add_f32 v[4:5], v[4:5], v[28:29]
    v_pk_add_f32 v[6:7], v[6:7], v[30:31]
    v_pk_add_f32 v[8:9], v[8:9], v[32:33]
    v_pk_add_f32 v[10:11], v[10:11], v[34:35]
    v_pk_add_f32 v[12:13], v[12:13], v[36:37]
    v_pk_add_f32 v[14:15], v[14:15], v[38:39]
    v_pk_add_f32 v[4:5], v[4:5], v[40:41]
    v_pk_add_f32 v[6:7], v[6:7], v[42:43]
    v_pk_add_f32 v[8:9], v[8:9], v[44:45]
    v_pk_add_f32 v[10:11], v[10:11], v[46:47]
    v_pk_add_f32 v[12:13], v[12:13], v[48:49]
    v_pk_add_f32 v[14:15], v[14:15], v[50:51]
    v_pk_add_f32 v[4:5], v[4:5], v[52:53]
    v_pk_add_f32 v[6:7], v[6:7], v[54:55]
    v_pk_add_f32 v[8:9], v[8:9], v[56:57]
    v_pk_add_f32 v[10:11], v[10:11], v[58:59]
    v_pk_add_f32 v[12:13], v[12:13], v[60:61]
    v_pk_add_f32 v[14:15], v[14:15], v[62:63]
    v_pk_add_f32 v[4:5], v[4:5], v[64:65]
    v_pk_add_f32 v[6:7], v[6:7], v[66:67]
    v_pk_add_f32 v[8:9], v[8:9], v[68:69]
    v_pk_add_f32 v[10:11], v[10:11], v[70:71]
    v_pk_add_f32 v[12:13], v[12:13], v[72:73]
    v_pk_add_f32 v[14:15], v[14:15], v[74:75]
    v_pk_add_f32 v[4:5], v[4:5], v[76:77]
    v_pk_add_f32 v[6:7], v[6:7], v[78:79]
    v_pk_add_f32 v[8:9], v[8:9], v[80:81]
    v_pk_add_f32 v[10:11], v[10:11], v[82:83]
    v_pk_add_f32 v[12:13], v[12:13], v[84:85]
    v_pk_add_f32 v[14:15], v[14:15], v[86:87]
    v_pk_add_f32 v[4:5], v[4:5], v[88:89]
    v_pk_add_f32 v[6:7], v[6:7], v[90:91]
    v_pk_add_f32 v[8:9], v[8:9], v[92:93]
    v_pk_add_f32 v[10:11], v[10:11], v[94:95]
    v_pk_add_f32 v[12:13], v[12:13], v[96:97]
    v_pk_add_f32 v[14:15], v[14:15], v[98:99]
    ds_write_b128 v101, v[4:7] offset:0
    ds_write_b128 v101, v[8:11] offset:128
    s_mov_b64 exec, vcc
    ds_write_b128 v101, v[12:15] offset:256
    s_mov_b64 exec, -1
L2_hdone:
    s_waitcnt vmcnt(0) lgkmcnt(0)
L2_hend:
    s_and_b32 s20, s2, 7
    s_lshl_b32 s20, s20, 2
    s_lshr_b32 s28, s2, 6
    s_add_u32 s20, s20, s28
    s_bfe_u32 s21, s2, 0x30003
    s_add_u32 s36, s4, 0xb0a000
    s_addc_u32 s37, s5, 0
    s_mov_b32 s8, s62
    s_mov_b32 s9, s63
    s_mov_b32 s10, 0x280000
    s_mov_b32 s11, 0x20000
    s_mov_b32 s56, s60
    s_mov_b32 s57, s61
    s_mov_b32 s58, 0x280000
    s_mov_b32 s59, 0x20000
    s_load_dwordx16 s[64:79], s[36:37], 0
    s_lshl_b32 s25, s20, 2
    s_add_u32 s25, s25, s18
    v_and_b32 v86, 15, v0
    v_lshrrev_b32 v87, 4, v0
    s_lshl_b32 s28, s25, 4
    v_add_u32 v86, s28, v86
    v_mul_u32_u24 v89, 1280, v86
    v_mul_u32_u24 v87, 40, v87
    s_mul_i32 s28, s21, 160
    v_add3_u32 v89, v89, v87, s28
    v_lshlrev_b32 v2, 2, v86
    s_mov_b32 s28, 0xb00000
    s_mov_b32 s29, 0xb02000
    buffer_load_dwordx4 v[4:7], v89, s[8:11], 0 offen
    buffer_load_dwordx4 v[8:11], v89, s[8:11], 0 offen offset:16
    buffer_load_dwordx2 v[12:13], v89, s[8:11], 0 offen offset:32
    buffer_load_dword v84, v2, s[12:15], s28 offen sc1
    buffer_load_dword v85, v2, s[12:15], s29 offen sc1
    s_setprio 0
    s_waitcnt lgkmcnt(0)
    s_barrier
    s_barrier
    s_barrier
    v_mov_b32 v44, 0
    v_mov_b32 v45, 0
    v_mov_b32 v46, 0
    v_mov_b32 v47, 0
    v_mov_b32 v48, 0
    v_mov_b32 v49, 0
    v_mov_b32 v50, 0
    v_mov_b32 v51, 0
    v_mov_b32 v52, 0
    v_mov_b32 v53, 0
    v_mov_b32 v54, 0
    v_mov_b32 v55, 0
    v_mov_b32 v56, 0
    v_mov_b32 v57, 0
    v_mov_b32 v58, 0
    v_mov_b32 v59, 0
    v_mov_b32 v60, 0
    v_mov_b32 v61, 0
    v_mov_b32 v62, 0
    v_mov_b32 v63, 0
    s_mov_b64 s[38:39], 0
    v_cmp_eq_u32 vcc, s64, v86
    v_mov_b32 v24, 0
    v_mov_b32 v25, s72
    s_or_b64 s[38:39], s[38:39], vcc
    v_cndmask_b32 v2, v2, v24, vcc
    v_cndmask_b32 v88, v88, v25, vcc
    v_cmp_eq_u32 vcc, s65, v86
    v_mov_b32 v24, 320
    v_mov_b32 v25, s73
    s_or_b64 s[38:39], s[38:39], vcc
    v_cndmask_b32 v2, v2, v24, vcc
    v_cndmask_b32 v88, v88, v25, vcc
    v_cmp_eq_u32 vcc, s66, v86
    v_mov_b32 v24, 640
    v_mov_b32 v25, s74
    s_or_b64 s[38:39], s[38:39], vcc
    v_cndmask_b32 v2, v2, v24, vcc
    v_cndmask_b32 v88, v88, v25, vcc
    v_cmp_eq_u32 vcc, s67, v86
    v_mov_b32 v24, 960
    v_mov_b32 v25, s75
    s_or_b64 s[38:39], s[38:39], vcc
    v_cndmask_b32 v2, v2, v24, vcc
    v_cndmask_b32 v88, v88, v25, vcc
    v_cmp_eq_u32 vcc, s68, v86
    v_mov_b32 v24, 1280
    v_mov_b32 v25, s76
    s_or_b64 s[38:39], s[38:39], vcc
    v_cndmask_b32 v2, v2, v24, vcc
    v_cndmask_b32 v88, v88, v25, vcc
    v_cmp_eq_u32 vcc, s69, v86
    v_mov_b32 v24, 1600
    v_mov_b32 v25, s77
    s_or_b64 s[38:39], s[38:39], vcc
    v_cndmask_b32 v2, v2, v24, vcc
    v_cndmask_b32 v88, v88, v25, vcc
    v_cmp_eq_u32 vcc, s70, v86
    v_mov_b32 v24, 1920
    v_mov_b32 v25, s78
    s_or_b64 s[38:39], s[38:39], vcc
    v_cndmask_b32 v2, v2, v24, vcc
    v_cndmask_b32 v88, v88, v25, vcc
    v_cmp_eq_u32 vcc, s71, v86
    v_mov_b32 v24, 2240
    v_mov_b32 v25, s79
    s_or_b64 s[38:39], s[38:39], vcc
    v_cndmask_b32 v2, v2, v24, vcc
    v_cndmask_b32 v88, v88, v25, vcc
    s_cbranch_scc0 L2_noupd
    v_lshl_add_u32 v2, v87, 1, v2
    s_mov_b64 exec, s[38:39]
    ds_read_b128 v[44:47], v2 offset:0
    ds_read_b128 v[48:51], v2 offset:16
    ds_read_b128 v[52:55], v2 offset:32
    ds_read_b128 v[56:59], v2 offset:48
    ds_read_b128 v[60:63], v2 offset:64
    s_waitcnt lgkmcnt(0)
    v_cvt_pk_bf16_f32 v44, v44, v44
    v_and_b32 v44, 0xffff0000, v44
    v_cvt_pk_bf16_f32 v45, v45, v45
    v_and_b32 v45, 0xffff0000, v45
    v_cvt_pk_bf16_f32 v46, v46, v46
    v_and_b32 v46, 0xffff0000, v46
    v_cvt_pk_bf16_f32 v47, v47, v47
    v_and_b32 v47, 0xffff0000, v47
    v_cvt_pk_bf16_f32 v48, v48, v48
    v_and_b32 v48, 0xffff0000, v48
    v_cvt_pk_bf16_f32 v49, v49, v49
    v_and_b32 v49, 0xffff0000, v49
    v_cvt_pk_bf16_f32 v50, v50, v50
    v_and_b32 v50, 0xffff0000, v50
    v_cvt_pk_bf16_f32 v51, v51, v51
    v_and_b32 v51, 0xffff0000, v51
    v_cvt_pk_bf16_f32 v52, v52, v52
    v_and_b32 v52, 0xffff0000, v52
    v_cvt_pk_bf16_f32 v53, v53, v53
    v_and_b32 v53, 0xffff0000, v53
    v_cvt_pk_bf16_f32 v54, v54, v54
    v_and_b32 v54, 0xffff0000, v54
    v_cvt_pk_bf16_f32 v55, v55, v55
    v_and_b32 v55, 0xffff0000, v55
    v_cvt_pk_bf16_f32 v56, v56, v56
    v_and_b32 v56, 0xffff0000, v56
    v_cvt_pk_bf16_f32 v57, v57, v57
    v_and_b32 v57, 0xffff0000, v57
    v_cvt_pk_bf16_f32 v58, v58, v58
    v_and_b32 v58, 0xffff0000, v58
    v_cvt_pk_bf16_f32 v59, v59, v59
    v_and_b32 v59, 0xffff0000, v59
    v_cvt_pk_bf16_f32 v60, v60, v60
    v_and_b32 v60, 0xffff0000, v60
    v_cvt_pk_bf16_f32 v61, v61, v61
    v_and_b32 v61, 0xffff0000, v61
    v_cvt_pk_bf16_f32 v62, v62, v62
    v_and_b32 v62, 0xffff0000, v62
    v_cvt_pk_bf16_f32 v63, v63, v63
    v_and_b32 v63, 0xffff0000, v63
    v_mul_f32 v44, v44, v88
    v_mul_f32 v45, v45, v88
    v_mul_f32 v46, v46, v88
    v_mul_f32 v47, v47, v88
    v_mul_f32 v48, v48, v88
    v_mul_f32 v49, v49, v88
    v_mul_f32 v50, v50, v88
    v_mul_f32 v51, v51, v88
    v_mul_f32 v52, v52, v88
    v_mul_f32 v53, v53, v88
    v_mul_f32 v54, v54, v88
    v_mul_f32 v55, v55, v88
    v_mul_f32 v56, v56, v88
    v_mul_f32 v57, v57, v88
    v_mul_f32 v58, v58, v88
    v_mul_f32 v59, v59, v88
    v_mul_f32 v60, v60, v88
    v_mul_f32 v61, v61, v88
    v_mul_f32 v62, v62, v88
    v_mul_f32 v63, v63, v88
    v_cvt_pk_bf16_f32 v44, v44, v44
    v_and_b32 v44, 0xffff0000, v44
    v_cvt_pk_bf16_f32 v45, v45, v45
    v_and_b32 v45, 0xffff0000, v45
    v_cvt_pk_bf16_f32 v46, v46, v46
    v_and_b32 v46, 0xffff0000, v46
    v_cvt_pk_bf16_f32 v47, v47, v47
    v_and_b32 v47, 0xffff0000, v47
    v_cvt_pk_bf16_f32 v48, v48, v48
    v_and_b32 v48, 0xffff0000, v48
    v_cvt_pk_bf16_f32 v49, v49, v49
    v_and_b32 v49, 0xffff0000, v49
    v_cvt_pk_bf16_f32 v50, v50, v50
    v_and_b32 v50, 0xffff0000, v50
    v_cvt_pk_bf16_f32 v51, v51, v51
    v_and_b32 v51, 0xffff0000, v51
    v_cvt_pk_bf16_f32 v52, v52, v52
    v_and_b32 v52, 0xffff0000, v52
    v_cvt_pk_bf16_f32 v53, v53, v53
    v_and_b32 v53, 0xffff0000, v53
    v_cvt_pk_bf16_f32 v54, v54, v54
    v_and_b32 v54, 0xffff0000, v54
    v_cvt_pk_bf16_f32 v55, v55, v55
    v_and_b32 v55, 0xffff0000, v55
    v_cvt_pk_bf16_f32 v56, v56, v56
    v_and_b32 v56, 0xffff0000, v56
    v_cvt_pk_bf16_f32 v57, v57, v57
    v_and_b32 v57, 0xffff0000, v57
    v_cvt_pk_bf16_f32 v58, v58, v58
    v_and_b32 v58, 0xffff0000, v58
    v_cvt_pk_bf16_f32 v59, v59, v59
    v_and_b32 v59, 0xffff0000, v59
    v_cvt_pk_bf16_f32 v60, v60, v60
    v_and_b32 v60, 0xffff0000, v60
    v_cvt_pk_bf16_f32 v61, v61, v61
    v_and_b32 v61, 0xffff0000, v61
    v_cvt_pk_bf16_f32 v62, v62, v62
    v_and_b32 v62, 0xffff0000, v62
    v_cvt_pk_bf16_f32 v63, v63, v63
    v_and_b32 v63, 0xffff0000, v63
    s_mov_b64 exec, -1
L2_noupd:
    s_waitcnt vmcnt(0)
    v_lshlrev_b32 v64, 16, v4
    v_and_b32 v65, 0xffff0000, v4
    v_lshlrev_b32 v66, 16, v5
    v_and_b32 v67, 0xffff0000, v5
    v_lshlrev_b32 v68, 16, v6
    v_and_b32 v69, 0xffff0000, v6
    v_lshlrev_b32 v70, 16, v7
    v_and_b32 v71, 0xffff0000, v7
    v_lshlrev_b32 v72, 16, v8
    v_and_b32 v73, 0xffff0000, v8
    v_lshlrev_b32 v74, 16, v9
    v_and_b32 v75, 0xffff0000, v9
    v_lshlrev_b32 v76, 16, v10
    v_and_b32 v77, 0xffff0000, v10
    v_lshlrev_b32 v78, 16, v11
    v_and_b32 v79, 0xffff0000, v11
    v_lshlrev_b32 v80, 16, v12
    v_and_b32 v81, 0xffff0000, v12
    v_lshlrev_b32 v82, 16, v13
    v_and_b32 v83, 0xffff0000, v13
    v_sub_f32 v24, v64, v84
    v_sub_f32 v25, v65, v84
    v_sub_f32 v26, v66, v84
    v_sub_f32 v27, v67, v84
    v_sub_f32 v28, v68, v84
    v_sub_f32 v29, v69, v84
    v_sub_f32 v30, v70, v84
    v_sub_f32 v31, v71, v84
    v_sub_f32 v32, v72, v84
    v_sub_f32 v33, v73, v84
    v_sub_f32 v34, v74, v84
    v_sub_f32 v35, v75, v84
    v_sub_f32 v36, v76, v84
    v_sub_f32 v37, v77, v84
    v_sub_f32 v38, v78, v84
    v_sub_f32 v39, v79, v84
    v_sub_f32 v40, v80, v84
    v_sub_f32 v41, v81, v84
    v_sub_f32 v42, v82, v84
    v_sub_f32 v43, v83, v84
    v_cvt_pk_bf16_f32 v14, v24, v25
    v_cvt_pk_bf16_f32 v15, v26, v27
    v_cvt_pk_bf16_f32 v16, v28, v29
    v_cvt_pk_bf16_f32 v17, v30, v31
    v_cvt_pk_bf16_f32 v18, v32, v33
    v_cvt_pk_bf16_f32 v19, v34, v35
    v_cvt_pk_bf16_f32 v20, v36, v37
    v_cvt_pk_bf16_f32 v21, v38, v39
    v_cvt_pk_bf16_f32 v22, v40, v41
    v_cvt_pk_bf16_f32 v23, v42, v43
    v_lshlrev_b32 v24, 16, v14
    v_and_b32 v25, 0xffff0000, v14
    v_lshlrev_b32 v26, 16, v15
    v_and_b32 v27, 0xffff0000, v15
    v_lshlrev_b32 v28, 16, v16
    v_and_b32 v29, 0xffff0000, v16
    v_lshlrev_b32 v30, 16, v17
    v_and_b32 v31, 0xffff0000, v17
    v_lshlrev_b32 v32, 16, v18
    v_and_b32 v33, 0xffff0000, v18
    v_lshlrev_b32 v34, 16, v19
    v_and_b32 v35, 0xffff0000, v19
    v_lshlrev_b32 v36, 16, v20
    v_and_b32 v37, 0xffff0000, v20
    v_lshlrev_b32 v38, 16, v21
    v_and_b32 v39, 0xffff0000, v21
    v_lshlrev_b32 v40, 16, v22
    v_and_b32 v41, 0xffff0000, v22
    v_lshlrev_b32 v42, 16, v23
    v_and_b32 v43, 0xffff0000, v23
    v_mul_f32 v24, v24, v85
    v_mul_f32 v25, v25, v85
    v_mul_f32 v26, v26, v85
    v_mul_f32 v27, v27, v85
    v_mul_f32 v28, v28, v85
    v_mul_f32 v29, v29, v85
    v_mul_f32 v30, v30, v85
    v_mul_f32 v31, v31, v85
    v_mul_f32 v32, v32, v85
    v_mul_f32 v33, v33, v85
    v_mul_f32 v34, v34, v85
    v_mul_f32 v35, v35, v85
    v_mul_f32 v36, v36, v85
    v_mul_f32 v37, v37, v85
    v_mul_f32 v38, v38, v85
    v_mul_f32 v39, v39, v85
    v_mul_f32 v40, v40, v85
    v_mul_f32 v41, v41, v85
    v_mul_f32 v42, v42, v85
    v_mul_f32 v43, v43, v85
    v_cvt_pk_bf16_f32 v14, v24, v25
    v_cvt_pk_bf16_f32 v15, v26, v27
    v_cvt_pk_bf16_f32 v16, v28, v29
    v_cvt_pk_bf16_f32 v17, v30, v31
    v_cvt_pk_bf16_f32 v18, v32, v33
    v_cvt_pk_bf16_f32 v19, v34, v35
    v_cvt_pk_bf16_f32 v20, v36, v37
    v_cvt_pk_bf16_f32 v21, v38, v39
    v_cvt_pk_bf16_f32 v22, v40, v41
    v_cvt_pk_bf16_f32 v23, v42, v43
    v_lshlrev_b32 v24, 16, v14
    v_and_b32 v25, 0xffff0000, v14
    v_lshlrev_b32 v26, 16, v15
    v_and_b32 v27, 0xffff0000, v15
    v_lshlrev_b32 v28, 16, v16
    v_and_b32 v29, 0xffff0000, v16
    v_lshlrev_b32 v30, 16, v17
    v_and_b32 v31, 0xffff0000, v17
    v_lshlrev_b32 v32, 16, v18
    v_and_b32 v33, 0xffff0000, v18
    v_lshlrev_b32 v34, 16, v19
    v_and_b32 v35, 0xffff0000, v19
    v_lshlrev_b32 v36, 16, v20
    v_and_b32 v37, 0xffff0000, v20
    v_lshlrev_b32 v38, 16, v21
    v_and_b32 v39, 0xffff0000, v21
    v_lshlrev_b32 v40, 16, v22
    v_and_b32 v41, 0xffff0000, v22
    v_lshlrev_b32 v42, 16, v23
    v_and_b32 v43, 0xffff0000, v23
    v_add_f32 v44, v44, v24
    v_add_f32 v45, v45, v25
    v_add_f32 v46, v46, v26
    v_add_f32 v47, v47, v27
    v_add_f32 v48, v48, v28
    v_add_f32 v49, v49, v29
    v_add_f32 v50, v50, v30
    v_add_f32 v51, v51, v31
    v_add_f32 v52, v52, v32
    v_add_f32 v53, v53, v33
    v_add_f32 v54, v54, v34
    v_add_f32 v55, v55, v35
    v_add_f32 v56, v56, v36
    v_add_f32 v57, v57, v37
    v_add_f32 v58, v58, v38
    v_add_f32 v59, v59, v39
    v_add_f32 v60, v60, v40
    v_add_f32 v61, v61, v41
    v_add_f32 v62, v62, v42
    v_add_f32 v63, v63, v43
    v_mul_f32 v24, 0xbfb8aa3b, v44
    v_mul_f32 v25, 0xbfb8aa3b, v45
    v_mul_f32 v26, 0xbfb8aa3b, v46
    v_mul_f32 v27, 0xbfb8aa3b, v47
    v_mul_f32 v28, 0xbfb8aa3b, v48
    v_mul_f32 v29, 0xbfb8aa3b, v49
    v_mul_f32 v30, 0xbfb8aa3b, v50
    v_mul_f32 v31, 0xbfb8aa3b, v51
    v_mul_f32 v32, 0xbfb8aa3b, v52
    v_mul_f32 v33, 0xbfb8aa3b, v53
    v_mul_f32 v34, 0xbfb8aa3b, v54
    v_mul_f32 v35, 0xbfb8aa3b, v55
    v_mul_f32 v36, 0xbfb8aa3b, v56
    v_mul_f32 v37, 0xbfb8aa3b, v57
    v_mul_f32 v38, 0xbfb8aa3b, v58
    v_mul_f32 v39, 0xbfb8aa3b, v59
    v_mul_f32 v40, 0xbfb8aa3b, v60
    v_mul_f32 v41, 0xbfb8aa3b, v61
    v_mul_f32 v42, 0xbfb8aa3b, v62
    v_mul_f32 v43, 0xbfb8aa3b, v63
    v_exp_f32 v24, v24
    v_exp_f32 v25, v25
    v_exp_f32 v26, v26
    v_exp_f32 v27, v27
    v_exp_f32 v28, v28
    v_exp_f32 v29, v29
    v_exp_f32 v30, v30
    v_exp_f32 v31, v31
    v_exp_f32 v32, v32
    v_exp_f32 v33, v33
    v_exp_f32 v34, v34
    v_exp_f32 v35, v35
    v_exp_f32 v36, v36
    v_exp_f32 v37, v37
    v_exp_f32 v38, v38
    v_exp_f32 v39, v39
    v_exp_f32 v40, v40
    v_exp_f32 v41, v41
    v_exp_f32 v42, v42
    v_exp_f32 v43, v43
    v_add_f32 v24, 1.0, v24
    v_add_f32 v25, 1.0, v25
    v_add_f32 v26, 1.0, v26
    v_add_f32 v27, 1.0, v27
    v_add_f32 v28, 1.0, v28
    v_add_f32 v29, 1.0, v29
    v_add_f32 v30, 1.0, v30
    v_add_f32 v31, 1.0, v31
    v_add_f32 v32, 1.0, v32
    v_add_f32 v33, 1.0, v33
    v_add_f32 v34, 1.0, v34
    v_add_f32 v35, 1.0, v35
    v_add_f32 v36, 1.0, v36
    v_add_f32 v37, 1.0, v37
    v_add_f32 v38, 1.0, v38
    v_add_f32 v39, 1.0, v39
    v_add_f32 v40, 1.0, v40
    v_add_f32 v41, 1.0, v41
    v_add_f32 v42, 1.0, v42
    v_add_f32 v43, 1.0, v43
    v_rcp_f32 v24, v24
    v_rcp_f32 v25, v25
    v_rcp_f32 v26, v26
    v_rcp_f32 v27, v27
    v_rcp_f32 v28, v28
    v_rcp_f32 v29, v29
    v_rcp_f32 v30, v30
    v_rcp_f32 v31, v31
    v_rcp_f32 v32, v32
    v_rcp_f32 v33, v33
    v_rcp_f32 v34, v34
    v_rcp_f32 v35, v35
    v_rcp_f32 v36, v36
    v_rcp_f32 v37, v37
    v_rcp_f32 v38, v38
    v_rcp_f32 v39, v39
    v_rcp_f32 v40, v40
    v_rcp_f32 v41, v41
    v_rcp_f32 v42, v42
    v_rcp_f32 v43, v43
    v_mul_f32 v44, v44, v24
    v_mul_f32 v45, v45, v25
    v_mul_f32 v46, v46, v26
    v_mul_f32 v47, v47, v27
    v_mul_f32 v48, v48, v28
    v_mul_f32 v49, v49, v29
    v_mul_f32 v50, v50, v30
    v_mul_f32 v51, v51, v31
    v_mul_f32 v52, v52, v32
    v_mul_f32 v53, v53, v33
    v_mul_f32 v54, v54, v34
    v_mul_f32 v55, v55, v35
    v_mul_f32 v56, v56, v36
    v_mul_f32 v57, v57, v37
    v_mul_f32 v58, v58, v38
    v_mul_f32 v59, v59, v39
    v_mul_f32 v60, v60, v40
    v_mul_f32 v61, v61, v41
    v_mul_f32 v62, v62, v42
    v_mul_f32 v63, v63, v43
    s_mul_i32 s28, s18, 5120
    s_add_u32 s28, s28, 143360
    v_add_u32 v90, s28, v1
    s_mul_i32 s28, s18, 7168
    s_add_u32 s28, s28, 66048
    v_add_u32 v91, s28, v1
    s_lshl_b32 s28, s18, 11
    s_add_u32 s28, s28, 2560
    v_add_u32 v3, s28, v1
    s_barrier
    ds_read_b128 v[24:27], v90 offset:0
    ds_read_b128 v[104:107], v91 offset:0
    ds_read_b128 v[28:31], v90 offset:1024
    ds_read_b128 v[108:111], v91 offset:1024
    ds_read_b128 v[32:35], v90 offset:2048
    ds_read_b128 v[112:115], v91 offset:2048
    ds_read_b128 v[36:39], v90 offset:3072
    ds_read_b128 v[116:119], v3 offset:0
    ds_read_b128 v[40:43], v90 offset:4096
    ds_read_b128 v[120:123], v3 offset:1024
    s_waitcnt lgkmcnt(8)
    v_add_f32 v24, v24, v104
    v_fmac_f32 v64, v24, v44
    v_add_f32 v25, v25, v105
    v_fmac_f32 v65, v25, v45
    v_cvt_pk_bf16_f32 v4, v64, v65
    v_add_f32 v26, v26, v106
    v_fmac_f32 v66, v26, v46
    v_add_f32 v27, v27, v107
    v_fmac_f32 v67, v27, v47
    v_cvt_pk_bf16_f32 v5, v66, v67
    s_waitcnt lgkmcnt(6)
    v_add_f32 v28, v28, v108
    v_fmac_f32 v68, v28, v48
    v_add_f32 v29, v29, v109
    v_fmac_f32 v69, v29, v49
    v_cvt_pk_bf16_f32 v6, v68, v69
    v_add_f32 v30, v30, v110
    v_fmac_f32 v70, v30, v50
    v_add_f32 v31, v31, v111
    v_fmac_f32 v71, v31, v51
    v_cvt_pk_bf16_f32 v7, v70, v71
    buffer_store_dwordx4 v[4:7], v89, s[56:59], 0 offen
    s_waitcnt lgkmcnt(4)
    v_add_f32 v32, v32, v112
    v_fmac_f32 v72, v32, v52
    v_add_f32 v33, v33, v113
    v_fmac_f32 v73, v33, v53
    v_cvt_pk_bf16_f32 v8, v72, v73
    v_add_f32 v34, v34, v114
    v_fmac_f32 v74, v34, v54
    v_add_f32 v35, v35, v115
    v_fmac_f32 v75, v35, v55
    v_cvt_pk_bf16_f32 v9, v74, v75
    s_waitcnt lgkmcnt(2)
    v_add_f32 v36, v36, v116
    v_fmac_f32 v76, v36, v56
    v_add_f32 v37, v37, v117
    v_fmac_f32 v77, v37, v57
    v_cvt_pk_bf16_f32 v10, v76, v77
    v_add_f32 v38, v38, v118
    v_fmac_f32 v78, v38, v58
    v_add_f32 v39, v39, v119
    v_fmac_f32 v79, v39, v59
    v_cvt_pk_bf16_f32 v11, v78, v79
    buffer_store_dwordx4 v[8:11], v89, s[56:59], 0 offen offset:16
    s_waitcnt lgkmcnt(0)
    v_add_f32 v40, v40, v120
    v_fmac_f32 v80, v40, v60
    v_add_f32 v41, v41, v121
    v_fmac_f32 v81, v41, v61
    v_cvt_pk_bf16_f32 v12, v80, v81
    v_add_f32 v42, v42, v122
    v_fmac_f32 v82, v42, v62
    v_add_f32 v43, v43, v123
    v_fmac_f32 v83, v43, v63
    v_cvt_pk_bf16_f32 v13, v82, v83
    buffer_store_dwordx2 v[12:13], v89, s[56:59], 0 offen offset:32
    s_endpgm
L2_code_end:
L_code_end:
    s_endpgm
.section .rodata,"a"
.p2align 6
.amdhsa_kernel qkv_kernel
  .amdhsa_next_free_vgpr 168
  .amdhsa_next_free_sgpr 80
  .amdhsa_accum_offset 168
  .amdhsa_group_segment_fixed_size 0
  .amdhsa_kernarg_size 88
  .amdhsa_user_sgpr_count 2
  .amdhsa_user_sgpr_kernarg_segment_ptr 1
  .amdhsa_system_sgpr_workgroup_id_x 1
.end_amdhsa_kernel
.section .rodata,"a"
.p2align 6
.amdhsa_kernel attn_kernel
  .amdhsa_next_free_vgpr 168
  .amdhsa_next_free_sgpr 80
  .amdhsa_accum_offset 168
  .amdhsa_group_segment_fixed_size 0
  .amdhsa_kernarg_size 88
  .amdhsa_user_sgpr_count 2
  .amdhsa_user_sgpr_kernarg_segment_ptr 1
  .amdhsa_system_sgpr_workgroup_id_x 1
.end_amdhsa_kernel
```
